```python
import torch

def _softmax(x, axis=-1):
    return torch.softmax(x, dim=axis)
def _gelu(x):
    return torch.nn.functional.gelu(x, approximate="tanh")
def _silu(x):
    return torch.nn.functional.silu(x)
def _sigmoid(x):
    return torch.sigmoid(x)
def _layernorm(x, axis=-1, eps=1e-5):
    m = x.mean(dim=axis, keepdim=True)
    v = x.var(dim=axis, keepdim=True, unbiased=False)
    return (x - m) / torch.sqrt(v + eps)
def _scatter_add(tgt, idx, src, axis=0):
    return tgt.clone().index_add_(axis, idx, src)
def _segment_sum(src, seg, n):
    out = torch.zeros((n,) + src.shape[1:], dtype=src.dtype)
    return out.index_add_(0, seg, src)
def _pad(x, pw):
    flat = tuple(v for pair in reversed(pw) for v in pair)
    return torch.nn.functional.pad(x, flat)

kernel_name = 'gated_mix__sliding_block_cached__mixer_channel_mlp__decode'

def setup_inputs():

    _w = (lambda a: (lambda t: t.to(torch.bfloat16) if t.is_floating_point() else t)(torch.as_tensor(a)))
    def _A_setup():
        B, Sq, D = 8, 1, 448
        Hq, Hkv, Sk, Dh = 16, 8, 4096, 256
        assert Hq % Hkv == 0, (Hq, Hkv)
        return {
            "x": _w((lambda *s: torch.randn(*s, dtype=torch.bfloat16) * 0.05)(B, Sq, D)),
            "k_cache": _w((lambda *s: torch.randn(*s, dtype=torch.bfloat16) * 6.4)(B, Hkv, Sk, Dh)),
            "v_cache": _w((lambda *s: torch.randn(*s, dtype=torch.bfloat16) * 0.4)(B, Hkv, Sk, Dh)),
            "wq": _w((lambda *s: torch.randn(*s, dtype=torch.bfloat16) * 6.4)(D, Hq * Dh) * (D ** -0.5)),
            "wo": _w((lambda *s: torch.randn(*s, dtype=torch.bfloat16) * 0.4)(Hq * Dh, D) * ((Hq * Dh) ** -0.5)),
        }
    _A_in = _A_setup()

    def _B_setup():
        B, S, D, F = 8, 1, 448, 1792
        return {
            "x": _w((lambda *s: torch.randn(*s, dtype=torch.bfloat16) * 0.05)(B, S, D)),
            "w1": _w((lambda *s: torch.randn(*s, dtype=torch.bfloat16) * 0.8)(D, F) * (D ** -0.5)),
            "b1": _w((lambda *s: torch.randn(*s, dtype=torch.bfloat16) * 0.8)(F)),
            "w2": _w((lambda *s: torch.randn(*s, dtype=torch.bfloat16) * 0.05)(F, D) * (F ** -0.5)),
            "b2": _w((lambda *s: torch.randn(*s, dtype=torch.bfloat16) * 0.05)(D)),
        }
    _B_in = _B_setup()

    return {
        "A_x": _A_in["x"],
        "A_k_cache": _A_in["k_cache"],
        "A_v_cache": _A_in["v_cache"],
        "A_wq": _A_in["wq"],
        "A_wo": _A_in["wo"],
        "B_x": _B_in["x"],
        "B_w1": _B_in["w1"],
        "B_b1": _B_in["b1"],
        "B_w2": _B_in["w2"],
        "B_b2": _B_in["b2"],
        "gate_w": _w((lambda *s: torch.randn(*s, dtype=torch.bfloat16) * 0.05)(448) * 16.0),
    }

def reference(A_x, A_k_cache, A_v_cache, A_wq, A_wo, B_x, B_w1, B_b1, B_w2, B_b2, gate_w):
    def _A_ref(x, k_cache, v_cache, wq, wo):
        B, Sq, D = x.shape
        Hq, Dh = 16, 256
        Hkv, Sk = k_cache.shape[1], k_cache.shape[2]
        W = min(4096, max(256, Sk // 4))
        rep = Hq // Hkv
        q = (lambda x, *d: x.permute(*d))((x @ wq).reshape(B, Sq, Hq, Dh), 0, 2, 1, 3)
        k = (lambda x, n, axis: torch.repeat_interleave(x, n, dim=axis))(k_cache[:, :, Sk - W:, :], rep, axis=1)
        v = (lambda x, n, axis: torch.repeat_interleave(x, n, dim=axis))(v_cache[:, :, Sk - W:, :], rep, axis=1)
        scores = torch.einsum("bhqd,bhkd->bhqk", q, k) * (Dh ** -0.5)
        p = _softmax(scores, axis=-1)
        o = torch.einsum("bhqk,bhkd->bhqd", p, v)
        return (lambda x, *d: x.permute(*d))(o, 0, 2, 1, 3).reshape(B, Sq, Hq * Dh) @ wo

    def _B_ref(x, w1, b1, w2, b2):
        y = _layernorm(x, axis=-1)
        h = _gelu(torch.einsum("bsd,df->bsf", y, w1) + b1)
        return torch.einsum("bsf,fd->bsd", h, w2) + b2

    x = A_x
    g = _sigmoid((x * gate_w).sum(-1, keepdims=True))
    a = _A_ref(x, A_k_cache, A_v_cache, A_wq, A_wo)
    b = _B_ref(x, B_w1, B_b1, B_w2, B_b2)
    return g * a + (1 - g) * b
```

```asm
; @launch grid=(256,1,1) block=(768,1,1) lds=111616
.amdgcn_target "amdgcn-amd-amdhsa--gfx950"
.text
.globl gated_mix__sliding_block_cached__mixer_channel_mlp__decode_kernel
.p2align 8
.type gated_mix__sliding_block_cached__mixer_channel_mlp__decode_kernel,@function
gated_mix__sliding_block_cached__mixer_channel_mlp__decode_kernel:
    s_cmp_ge_u32 s2, 256
    s_cbranch_scc1 L_end
    s_load_dwordx16 s[4:19], s[0:1], 0
    s_load_dwordx8 s[20:27], s[0:1], 64
    s_load_dwordx4 s[28:31], s[0:1], 96
    v_lshrrev_b32 v1, 6, v0
    v_and_b32 v0, 63, v0
    v_readfirstlane_b32 s3, v1
    s_and_b32 s35, s2, 7
    s_lshr_b32 s36, s2, 3
    s_and_b32 s37, s36, 7
    s_lshr_b32 s38, s36, 3
    s_sub_u32 s40, s36, 4
    s_cmp_lt_u32 s36, 4
    s_cselect_b32 s39, 255, s40
    s_mov_b32 s72, 0xffffff00
    s_mov_b32 s73, 0x0c0c0400
    s_cmp_ge_u32 s3, 8
    s_cbranch_scc1 L_helper
    s_mov_b32 s74, s3
    s_lshl_b32 s75, s37, 3
    s_add_u32 s75, s75, s35
    s_lshl_b32 s75, s75, 21
    s_lshl_b32 s76, s38, 17
    s_add_u32 s75, s75, s76
    s_add_u32 s75, s75, 0x180000
    s_mov_b32 s76, 0
    s_add_u32 s76, s76, s37
    s_add_u32 s76, s76, s35
    s_add_u32 s76, s76, s74
    s_lshl_b32 s77, s74, 14
    s_add_u32 s75, s75, s77
    s_and_b32 s76, s76, 7
    s_lshl_b32 s76, s76, 11
    s_add_u32 s40, s76, s75
    s_add_u32 s76, s76, 0x800
    s_and_b32 s76, s76, 0x3fff
    s_add_u32 s41, s76, s75
    s_add_u32 s76, s76, 0x800
    s_and_b32 s76, s76, 0x3fff
    s_add_u32 s42, s76, s75
    s_add_u32 s76, s76, 0x800
    s_and_b32 s76, s76, 0x3fff
    s_add_u32 s43, s76, s75
    s_add_u32 s76, s76, 0x800
    s_and_b32 s76, s76, 0x3fff
    s_add_u32 s44, s76, s75
    s_add_u32 s76, s76, 0x800
    s_and_b32 s76, s76, 0x3fff
    s_add_u32 s45, s76, s75
    s_add_u32 s76, s76, 0x800
    s_and_b32 s76, s76, 0x3fff
    s_add_u32 s46, s76, s75
    s_add_u32 s76, s76, 0x800
    s_and_b32 s76, s76, 0x3fff
    s_add_u32 s47, s76, s75
    v_lshrrev_b32 v3, 4, v0
    v_lshlrev_b32 v1, 6, v3
    v_bfe_u32 v4, v0, 2, 2
    v_lshl_add_u32 v1, v4, 9, v1
    v_and_b32 v4, 3, v0
    v_lshl_add_u32 v1, v4, 4, v1
    v_and_b32 v4, 15, v0
    v_lshlrev_b32 v4, 4, v4
    v_lshl_add_u32 v2, v3, 9, v4
    s_waitcnt lgkmcnt(0)
    s_load_dword s32, s[30:31], 0
    s_mov_b32 s14, 0x04000c0c
    s_mov_b32 s52, s6
    s_and_b32 s53, s7, 0xffff
    s_mov_b32 s54, 134217728
    s_mov_b32 s55, 0x20000
    buffer_load_dwordx4 v[8:11], v1, s[52:55], s40 offen offset:0 nt
    s_barrier
    s_mov_b32 s56, s8
    s_and_b32 s57, s9, 0xffff
    s_mov_b32 s58, 134217728
    s_mov_b32 s59, 0x20000
    s_mov_b32 s48, s30
    s_and_b32 s49, s31, 0xffff
    s_mov_b32 s50, 8388608
    s_mov_b32 s51, 0x20000
    buffer_load_dwordx4 v[12:15], v1, s[52:55], s40 offen offset:256 nt
    buffer_load_dwordx4 v[16:19], v1, s[52:55], s41 offen offset:0 nt
    buffer_load_dwordx4 v[20:23], v1, s[52:55], s41 offen offset:256 nt
    buffer_load_dwordx4 v[24:27], v1, s[52:55], s42 offen offset:0 nt
    s_waitcnt vmcnt(4)
    buffer_load_dwordx4 v[28:31], v1, s[52:55], s42 offen offset:256 nt
    s_waitcnt vmcnt(4)
    buffer_load_dwordx4 v[32:35], v1, s[52:55], s43 offen offset:0 nt
    s_waitcnt vmcnt(4)
    buffer_load_dwordx4 v[36:39], v1, s[52:55], s43 offen offset:256 nt
    s_waitcnt vmcnt(4)
    buffer_load_dwordx4 v[40:43], v1, s[52:55], s44 offen offset:0 nt
    s_waitcnt vmcnt(4)
    buffer_load_dwordx4 v[44:47], v1, s[52:55], s44 offen offset:256 nt
    s_waitcnt vmcnt(4)
    buffer_load_dwordx4 v[48:51], v1, s[52:55], s45 offen offset:0 nt
    s_waitcnt vmcnt(4)
    buffer_load_dwordx4 v[52:55], v1, s[52:55], s45 offen offset:256 nt
    s_waitcnt vmcnt(4)
    buffer_load_dwordx4 v[56:59], v1, s[52:55], s46 offen offset:0 nt
    s_waitcnt vmcnt(4)
    buffer_load_dwordx4 v[60:63], v1, s[52:55], s46 offen offset:256 nt
    s_waitcnt vmcnt(4)
    buffer_load_dwordx4 v[64:67], v1, s[52:55], s47 offen offset:0 nt
    s_waitcnt vmcnt(4)
    buffer_load_dwordx4 v[68:71], v1, s[52:55], s47 offen offset:256 nt
    s_waitcnt vmcnt(4)
    buffer_load_dwordx4 v[72:75], v2, s[56:59], s40 offen offset:0 nt
    s_waitcnt vmcnt(4)
    buffer_load_dwordx4 v[76:79], v2, s[56:59], s40 offen offset:256 nt
    s_waitcnt vmcnt(4)
    buffer_load_dwordx4 v[80:83], v2, s[56:59], s41 offen offset:0 nt
    s_waitcnt vmcnt(4)
    buffer_load_dwordx4 v[84:87], v2, s[56:59], s41 offen offset:256 nt
    s_waitcnt vmcnt(4)
    buffer_load_dwordx4 v[88:91], v2, s[56:59], s42 offen offset:0 nt
    s_waitcnt vmcnt(4)
    buffer_load_dwordx4 v[92:95], v2, s[56:59], s42 offen offset:256 nt
    buffer_load_dwordx4 v[96:99], v2, s[56:59], s43 offen offset:0 nt
    buffer_load_dwordx4 v[100:103], v2, s[56:59], s43 offen offset:256 nt
    buffer_load_dwordx4 v[104:107], v2, s[56:59], s44 offen offset:0 nt
    buffer_load_dwordx4 v[108:111], v2, s[56:59], s44 offen offset:256 nt
    buffer_load_dwordx4 v[112:115], v2, s[56:59], s45 offen offset:0 nt
    buffer_load_dwordx4 v[116:119], v2, s[56:59], s45 offen offset:256 nt
    buffer_load_dwordx4 v[120:123], v2, s[56:59], s46 offen offset:0 nt
    buffer_load_dwordx4 v[124:127], v2, s[56:59], s46 offen offset:256 nt
    buffer_load_dwordx4 v[128:131], v2, s[56:59], s47 offen offset:0 nt
    buffer_load_dwordx4 v[132:135], v2, s[56:59], s47 offen offset:256 nt
    v_mov_b32 v164, 109460
    v_mov_b32 v165, 1
    s_mov_b32 exec_lo, 0x1
    s_mov_b32 exec_hi, 0x0
    ds_add_u32 v164, v165
    s_mov_b64 exec, -1
    s_waitcnt lgkmcnt(0)
    s_add_u32 s32, s32, 1
    s_and_b32 s33, s32, 0xff
    s_mul_i32 s34, s33, 0x01010101
    s_mov_b32 s64, 0x22222222
    s_mov_b32 s65, 0x22222222
    s_mov_b32 s66, 0x44444444
    s_mov_b32 s67, 0x44444444
    s_mov_b32 s68, 0x88888888
    s_mov_b32 s69, 0x88888888
    s_mov_b32 s70, 0
    s_mov_b32 s71, -1
    v_lshrrev_b32 v7, 4, v0
    v_lshlrev_b32 v3, 6, v7
    v_bfe_u32 v164, v0, 2, 1
    v_lshl_add_u32 v3, v164, 9, v3
    v_and_b32 v164, 3, v0
    v_lshl_add_u32 v3, v164, 4, v3
    v_add_u32 v3, 88576, v3
    s_lshl_b32 s77, s74, 7
    s_add_u32 s77, s77, 89600
    v_bfe_u32 v164, v0, 2, 3
    v_lshlrev_b32 v4, 4, v164
    v_lshrrev_b32 v164, 5, v0
    v_lshl_add_u32 v4, v164, 3, v4
    v_and_b32 v164, 3, v0
    v_lshl_add_u32 v4, v164, 1, v4
    v_add_u32 v4, s77, v4
    v_bfe_u32 v164, v0, 3, 1
    v_lshlrev_b32 v5, 6, v164
    v_lshl_add_u32 v5, v7, 4, v5
    v_add_u32 v5, s77, v5
    s_lshl_b32 s77, s74, 11
    s_add_u32 s77, s77, 90624
    v_lshrrev_b32 v164, 5, v0
    v_lshlrev_b32 v6, 10, v164
    v_and_b32 v164, 15, v0
    v_lshl_add_u32 v6, v164, 5, v6
    v_bfe_u32 v164, v0, 4, 1
    v_lshl_add_u32 v6, v164, 4, v6
    v_add_u32 v6, s77, v6
    v_and_b32 v164, 1, v0
    v_cmp_eq_u32 vcc, 1, v164
    v_mov_b32 v165, 0x0c0c0100
    v_mov_b32 v166, 0x01000c0c
    v_cndmask_b32 v165, v165, v166, vcc
    v_mov_b32 v166, 0x0c0c0302
    v_mov_b32 v167, 0x03020c0c
    v_cndmask_b32 v166, v166, v167, vcc
    v_bfe_u32 v164, v0, 1, 2
    v_mov_b32 v167, 0x0c0c0c0c
    v_cmp_eq_u32 vcc, 0, v164
    s_nop 1
    v_cndmask_b32 v156, v167, v165, vcc
    v_cndmask_b32 v160, v167, v166, vcc
    v_cmp_eq_u32 vcc, 1, v164
    s_nop 1
    v_cndmask_b32 v157, v167, v165, vcc
    v_cndmask_b32 v161, v167, v166, vcc
    v_cmp_eq_u32 vcc, 2, v164
    s_nop 1
    v_cndmask_b32 v158, v167, v165, vcc
    v_cndmask_b32 v162, v167, v166, vcc
    v_cmp_eq_u32 vcc, 3, v164
    s_nop 1
    v_cndmask_b32 v159, v167, v165, vcc
    v_cndmask_b32 v163, v167, v166, vcc
    v_mov_b32 v164, 109452
    s_mov_b32 s81, 0
L_lw_1:
    ds_read_b32 v165, v164
    s_waitcnt lgkmcnt(0)
    v_readfirstlane_b32 s80, v165
    s_nop 0
    s_cmp_ge_u32 s80, 4
    s_cbranch_scc1 L_lwd_2
    s_add_u32 s81, s81, 1
    s_cmp_ge_u32 s81, 800000
    s_cbranch_scc1 L_lwd_2
    s_sleep 2
    s_branch L_lw_1
L_lwd_2:
    ds_read_b128 v[136:139], v3
    ds_read_b128 v[140:143], v3 offset:256
    s_waitcnt lgkmcnt(0)
    s_waitcnt vmcnt(30)
    v_mfma_f32_16x16x32_bf16 v[144:147], v[136:139], v[8:11], 0
    v_mfma_f32_16x16x32_bf16 v[144:147], v[140:143], v[12:15], v[144:147]
    s_waitcnt vmcnt(28)
    v_mfma_f32_16x16x32_bf16 v[8:11], v[136:139], v[16:19], 0
    v_mfma_f32_16x16x32_bf16 v[8:11], v[140:143], v[20:23], v[8:11]
    s_waitcnt vmcnt(26)
    v_mfma_f32_16x16x32_bf16 v[16:19], v[136:139], v[24:27], 0
    v_mfma_f32_16x16x32_bf16 v[16:19], v[140:143], v[28:31], v[16:19]
    s_waitcnt vmcnt(24)
    v_mfma_f32_16x16x32_bf16 v[24:27], v[136:139], v[32:35], 0
    v_mfma_f32_16x16x32_bf16 v[24:27], v[140:143], v[36:39], v[24:27]
    s_waitcnt vmcnt(22)
    v_mfma_f32_16x16x32_bf16 v[32:35], v[136:139], v[40:43], 0
    v_mfma_f32_16x16x32_bf16 v[32:35], v[140:143], v[44:47], v[32:35]
    s_waitcnt vmcnt(20)
    v_mfma_f32_16x16x32_bf16 v[40:43], v[136:139], v[48:51], 0
    v_mfma_f32_16x16x32_bf16 v[40:43], v[140:143], v[52:55], v[40:43]
    s_waitcnt vmcnt(18)
    v_mfma_f32_16x16x32_bf16 v[48:51], v[136:139], v[56:59], 0
    v_mfma_f32_16x16x32_bf16 v[48:51], v[140:143], v[60:63], v[48:51]
    s_waitcnt vmcnt(16)
    v_mfma_f32_16x16x32_bf16 v[56:59], v[136:139], v[64:67], 0
    v_mfma_f32_16x16x32_bf16 v[56:59], v[140:143], v[68:71], v[56:59]
    v_cndmask_b32 v148, v144, v145, s[64:65]
    v_cndmask_b32 v148, v148, v146, s[66:67]
    v_cndmask_b32 v148, v148, v147, s[68:69]
    v_cndmask_b32 v149, v8, v9, s[64:65]
    v_cndmask_b32 v149, v149, v10, s[66:67]
    v_cndmask_b32 v149, v149, v11, s[68:69]
    v_cndmask_b32 v150, v16, v17, s[64:65]
    v_cndmask_b32 v150, v150, v18, s[66:67]
    v_cndmask_b32 v150, v150, v19, s[68:69]
    v_cndmask_b32 v151, v24, v25, s[64:65]
    v_cndmask_b32 v151, v151, v26, s[66:67]
    v_cndmask_b32 v151, v151, v27, s[68:69]
    v_cndmask_b32 v152, v32, v33, s[64:65]
    v_cndmask_b32 v152, v152, v34, s[66:67]
    v_cndmask_b32 v152, v152, v35, s[68:69]
    v_cndmask_b32 v153, v40, v41, s[64:65]
    v_cndmask_b32 v153, v153, v42, s[66:67]
    v_cndmask_b32 v153, v153, v43, s[68:69]
    v_cndmask_b32 v154, v48, v49, s[64:65]
    v_cndmask_b32 v154, v154, v50, s[66:67]
    v_cndmask_b32 v154, v154, v51, s[68:69]
    v_cndmask_b32 v155, v56, v57, s[64:65]
    v_cndmask_b32 v155, v155, v58, s[66:67]
    v_cndmask_b32 v155, v155, v59, s[68:69]
    v_cndmask_b32 v148, v148, v152, s[70:71]
    v_cndmask_b32 v149, v149, v153, s[70:71]
    v_cndmask_b32 v150, v150, v154, s[70:71]
    v_cndmask_b32 v151, v151, v155, s[70:71]
    v_add_f32_dpp v148, v148, v148 quad_perm:[1,0,3,2] row_mask:0xf bank_mask:0xf
    v_add_f32_dpp v149, v149, v149 quad_perm:[1,0,3,2] row_mask:0xf bank_mask:0xf
    v_add_f32_dpp v150, v150, v150 quad_perm:[1,0,3,2] row_mask:0xf bank_mask:0xf
    v_add_f32_dpp v151, v151, v151 quad_perm:[1,0,3,2] row_mask:0xf bank_mask:0xf
    v_add_f32_dpp v148, v148, v148 quad_perm:[2,3,0,1] row_mask:0xf bank_mask:0xf
    v_add_f32_dpp v149, v149, v149 quad_perm:[2,3,0,1] row_mask:0xf bank_mask:0xf
    v_add_f32_dpp v150, v150, v150 quad_perm:[2,3,0,1] row_mask:0xf bank_mask:0xf
    v_add_f32_dpp v151, v151, v151 quad_perm:[2,3,0,1] row_mask:0xf bank_mask:0xf
    v_cndmask_b32 v152, v148, v149, s[64:65]
    v_cndmask_b32 v152, v152, v150, s[66:67]
    v_cndmask_b32 v152, v152, v151, s[68:69]
    v_cvt_pk_bf16_f32 v152, v152, v152
    v_and_b32 v152, 0xffff0000, v152
    v_mul_f32 v152, 0x3db8aa3b, v152
    v_mov_b32 v154, v152
    s_nop 1
    v_max_f32_dpp v154, v154, v154 row_ror:8 row_mask:0xf bank_mask:0xf
    s_nop 1
    v_max_f32_dpp v154, v154, v154 row_ror:4 row_mask:0xf bank_mask:0xf
    s_nop 1
    v_max_f32_dpp v154, v154, v154 row_ror:2 row_mask:0xf bank_mask:0xf
    s_nop 1
    v_max_f32_dpp v154, v154, v154 row_ror:1 row_mask:0xf bank_mask:0xf
    v_mov_b32 v153, v154
    s_nop 1
    v_permlane32_swap_b32 v154, v153
    v_max_f32 v154, v154, v153
    v_sub_f32 v155, v152, v154
    v_exp_f32 v155, v155
    s_nop 0
    v_cvt_pk_bf16_f32 v153, v155, v155
    ds_write_b16 v4, v153
    ds_read_b128 v[8:11], v5
    v_add_f32_dpp v155, v155, v155 row_ror:8 row_mask:0xf bank_mask:0xf
    s_nop 1
    v_add_f32_dpp v155, v155, v155 row_ror:4 row_mask:0xf bank_mask:0xf
    s_nop 1
    v_add_f32_dpp v155, v155, v155 row_ror:2 row_mask:0xf bank_mask:0xf
    s_nop 1
    v_add_f32_dpp v155, v155, v155 row_ror:1 row_mask:0xf bank_mask:0xf
    v_mov_b32 v148, v155
    s_nop 1
    v_permlane32_swap_b32 v155, v148
    v_add_f32 v155, v155, v148
    s_lshl_b32 s77, s74, 3
    s_add_u32 s77, s77, 107008
    v_bfe_u32 v164, v0, 4, 1
    v_lshlrev_b32 v164, 6, v164
    v_add_u32 v164, s77, v164
    s_mov_b32 exec_lo, 0x10001
    s_mov_b32 exec_hi, 0x0
    ds_write_b64 v164, v[154:155]
    v_mov_b32 v164, 109456
    v_mov_b32 v165, 1
    s_mov_b32 exec_lo, 0x1
    s_mov_b32 exec_hi, 0x0
    ds_add_u32 v164, v165
    s_mov_b64 exec, -1
    s_waitcnt lgkmcnt(2)
    v_perm_b32 v16, v8, v8, v156
    v_perm_b32 v17, v8, v8, v157
    v_perm_b32 v18, v8, v8, v158
    v_perm_b32 v19, v8, v8, v159
    s_waitcnt vmcnt(14)
    s_nop 0
    v_mfma_f32_16x16x32_bf16 v[136:139], v[16:19], v[72:75], 0
    v_mfma_f32_16x16x32_bf16 v[140:143], v[16:19], v[76:79], 0
    v_perm_b32 v20, v8, v8, v160
    v_perm_b32 v21, v8, v8, v161
    v_perm_b32 v22, v8, v8, v162
    v_perm_b32 v23, v8, v8, v163
    s_waitcnt vmcnt(12)
    s_nop 0
    v_mfma_f32_16x16x32_bf16 v[136:139], v[20:23], v[80:83], v[136:139]
    v_mfma_f32_16x16x32_bf16 v[140:143], v[20:23], v[84:87], v[140:143]
    v_perm_b32 v16, v9, v9, v156
    v_perm_b32 v17, v9, v9, v157
    v_perm_b32 v18, v9, v9, v158
    v_perm_b32 v19, v9, v9, v159
    s_waitcnt vmcnt(10)
    s_nop 0
    v_mfma_f32_16x16x32_bf16 v[136:139], v[16:19], v[88:91], v[136:139]
    v_mfma_f32_16x16x32_bf16 v[140:143], v[16:19], v[92:95], v[140:143]
    v_perm_b32 v20, v9, v9, v160
    v_perm_b32 v21, v9, v9, v161
    v_perm_b32 v22, v9, v9, v162
    v_perm_b32 v23, v9, v9, v163
    s_waitcnt vmcnt(8)
    s_nop 0
    v_mfma_f32_16x16x32_bf16 v[136:139], v[20:23], v[96:99], v[136:139]
    v_mfma_f32_16x16x32_bf16 v[140:143], v[20:23], v[100:103], v[140:143]
    v_perm_b32 v16, v10, v10, v156
    v_perm_b32 v17, v10, v10, v157
    v_perm_b32 v18, v10, v10, v158
    v_perm_b32 v19, v10, v10, v159
    s_waitcnt vmcnt(6)
    s_nop 0
    v_mfma_f32_16x16x32_bf16 v[136:139], v[16:19], v[104:107], v[136:139]
    v_mfma_f32_16x16x32_bf16 v[140:143], v[16:19], v[108:111], v[140:143]
    v_perm_b32 v20, v10, v10, v160
    v_perm_b32 v21, v10, v10, v161
    v_perm_b32 v22, v10, v10, v162
    v_perm_b32 v23, v10, v10, v163
    s_waitcnt vmcnt(4)
    s_nop 0
    v_mfma_f32_16x16x32_bf16 v[136:139], v[20:23], v[112:115], v[136:139]
    v_mfma_f32_16x16x32_bf16 v[140:143], v[20:23], v[116:119], v[140:143]
    s_lshl_b32 s77, s74, 8
    s_add_u32 s77, s77, 90624
    v_lshlrev_b32 v32, 2, v0
    v_add_u32 v3, s77, v32
    s_lshr_b32 s77, s74, 2
    s_lshl_b32 s77, s77, 6
    s_add_u32 s77, s77, 107008
    v_mov_b32 v4, s77
    v_mov_b32 v33, s33
    s_lshl_b32 s76, s35, 3
    s_add_u32 s76, s76, s37
    s_lshl_b32 s78, s76, 2
    s_add_u32 s78, s78, s38
    s_lshl_b32 s78, s78, 11
    s_lshl_b32 s79, s74, 8
    s_add_u32 s78, s78, s79
    s_add_u32 s46, s78, 458752
    s_lshl_b32 s77, s76, 1
    s_lshr_b32 s78, s74, 2
    s_add_u32 s77, s77, s78
    s_lshl_b32 s77, s77, 2
    s_add_u32 s77, s77, s38
    s_lshl_b32 s77, s77, 4
    s_add_u32 s45, s77, 983040
    v_mov_b32 v164, 109456
    s_mov_b32 s81, 0
L_lw_3:
    ds_read_b32 v165, v164
    s_waitcnt lgkmcnt(0)
    v_readfirstlane_b32 s80, v165
    s_nop 0
    s_cmp_ge_u32 s80, 8
    s_cbranch_scc1 L_lwd_4
    s_add_u32 s81, s81, 1
    s_cmp_ge_u32 s81, 800000
    s_cbranch_scc1 L_lwd_4
    s_sleep 2
    s_branch L_lw_3
L_lwd_4:
    ds_read_b128 v[40:43], v4 offset:0
    ds_read_b128 v[44:47], v4 offset:16
    ds_read_b128 v[48:51], v4 offset:32
    ds_read_b128 v[52:55], v4 offset:48
    s_lshl_b32 s76, s35, 3
    s_add_u32 s76, s76, s74
    s_and_b32 s78, s39, 3
    s_lshl_b32 s77, s76, 13
    s_lshl_b32 s79, s78, 9
    s_add_u32 s77, s77, s79
    s_add_u32 s40, s77, 458752
    s_add_u32 s41, s40, 4096
    s_lshl_b32 s77, s76, 1
    s_lshr_b32 s79, s78, 1
    s_add_u32 s77, s77, s79
    s_lshl_b32 s77, s77, 6
    s_add_u32 s44, s77, 983040
    v_lshrrev_b32 v34, 5, v0
    v_lshlrev_b32 v34, 11, v34
    v_and_b32 v35, 31, v0
    v_lshl_add_u32 v34, v35, 4, v34
    s_mul_i32 s77, s74, 272
    s_add_u32 s77, s77, 107136
    v_lshlrev_b32 v35, 3, v35
    v_add_u32 v35, s77, v35
    s_waitcnt lgkmcnt(0)
    v_max3_f32 v5, v40, v42, v44
    v_max3_f32 v30, v46, v48, v50
    v_max3_f32 v5, v5, v52, v54
    v_max_f32 v5, v5, v30
    v_and_b32 v5, s72, v5
    v_sub_f32 v40, v40, v5
    v_sub_f32 v42, v42, v5
    v_sub_f32 v44, v44, v5
    v_sub_f32 v46, v46, v5
    v_sub_f32 v48, v48, v5
    v_sub_f32 v50, v50, v5
    v_sub_f32 v52, v52, v5
    v_sub_f32 v54, v54, v5
    v_exp_f32 v40, v40
    v_exp_f32 v42, v42
    v_exp_f32 v44, v44
    v_exp_f32 v46, v46
    v_exp_f32 v48, v48
    v_exp_f32 v50, v50
    v_exp_f32 v52, v52
    v_exp_f32 v54, v54
    s_and_b32 s78, s74, 3
    s_cmp_lg_u32 s78, 0
    s_cbranch_scc1 L_nost_5
    v_mul_f32 v7, v40, v41
    v_fmac_f32 v7, v42, v43
    v_fmac_f32 v7, v44, v45
    v_fmac_f32 v7, v46, v47
    v_fmac_f32 v7, v48, v49
    v_fmac_f32 v7, v50, v51
    v_fmac_f32 v7, v52, v53
    v_fmac_f32 v7, v54, v55
    v_or_b32 v36, v5, v33
    v_and_or_b32 v37, v7, s72, v33
    v_mov_b32 v38, v33
    v_mov_b32 v39, v33
    v_mov_b32 v31, 0
L_nost_5:
    v_perm_b32 v16, v11, v11, v156
    v_perm_b32 v17, v11, v11, v157
    v_perm_b32 v18, v11, v11, v158
    v_perm_b32 v19, v11, v11, v159
    s_waitcnt vmcnt(2)
    s_nop 0
    v_mfma_f32_16x16x32_bf16 v[136:139], v[16:19], v[120:123], v[136:139]
    v_mfma_f32_16x16x32_bf16 v[140:143], v[16:19], v[124:127], v[140:143]
    v_perm_b32 v20, v11, v11, v160
    v_perm_b32 v21, v11, v11, v161
    v_perm_b32 v22, v11, v11, v162
    v_perm_b32 v23, v11, v11, v163
    s_waitcnt vmcnt(0)
    s_nop 0
    v_mfma_f32_16x16x32_bf16 v[136:139], v[20:23], v[128:131], v[136:139]
    v_mfma_f32_16x16x32_bf16 v[140:143], v[20:23], v[132:135], v[140:143]
    s_nop 6
    ds_write_b128 v6, v[136:139]
    ds_write_b128 v6, v[140:143] offset:512
    s_waitcnt lgkmcnt(0)
    s_barrier
    ds_read2st64_b32 v[8:9], v3 offset0:0 offset1:8
    ds_read2st64_b32 v[10:11], v3 offset0:16 offset1:24
    ds_read2st64_b32 v[12:13], v3 offset0:32 offset1:40
    ds_read2st64_b32 v[14:15], v3 offset0:48 offset1:56
    s_waitcnt lgkmcnt(2)
    v_mul_f32 v6, v40, v8
    v_mul_f32 v7, v42, v9
    v_fmac_f32 v6, v44, v10
    v_fmac_f32 v7, v46, v11
    s_waitcnt lgkmcnt(0)
    v_fmac_f32 v6, v48, v12
    v_fmac_f32 v7, v50, v13
    v_fmac_f32 v6, v52, v14
    v_fmac_f32 v7, v54, v15
    v_add_f32 v6, v6, v7
    v_and_or_b32 v6, v6, s72, v33
    buffer_store_dword v6, v32, s[48:51], s46 offen sc1
    s_and_b32 s78, s74, 3
    s_cmp_lg_u32 s78, 0
    s_cbranch_scc1 L_nost2_6
    s_mov_b32 exec_lo, 0x1
    s_mov_b32 exec_hi, 0x0
    buffer_store_dwordx4 v[36:39], v31, s[48:51], s45 offen sc1
    s_mov_b64 exec, -1
L_nost2_6:
    s_cmp_eq_u32 s39, 255
    s_cbranch_scc1 L_nogather_7
    s_add_u32 s78, s30, s44
    s_addc_u32 s79, s31, 0
    s_mov_b32 s81, 0
L_sp_8:
    s_load_dwordx16 s[52:67], s[78:79], 0 glc
    s_waitcnt lgkmcnt(0)
    s_xor_b32 s80, s52, s33
    s_xor_b32 s82, s53, s33
    s_or_b32 s80, s80, s82
    s_xor_b32 s82, s54, s33
    s_or_b32 s80, s80, s82
    s_xor_b32 s82, s55, s33
    s_or_b32 s80, s80, s82
    s_xor_b32 s82, s56, s33
    s_or_b32 s80, s80, s82
    s_xor_b32 s82, s57, s33
    s_or_b32 s80, s80, s82
    s_xor_b32 s82, s58, s33
    s_or_b32 s80, s80, s82
    s_xor_b32 s82, s59, s33
    s_or_b32 s80, s80, s82
    s_xor_b32 s82, s60, s33
    s_or_b32 s80, s80, s82
    s_xor_b32 s82, s61, s33
    s_or_b32 s80, s80, s82
    s_xor_b32 s82, s62, s33
    s_or_b32 s80, s80, s82
    s_xor_b32 s82, s63, s33
    s_or_b32 s80, s80, s82
    s_xor_b32 s82, s64, s33
    s_or_b32 s80, s80, s82
    s_xor_b32 s82, s65, s33
    s_or_b32 s80, s80, s82
    s_xor_b32 s82, s66, s33
    s_or_b32 s80, s80, s82
    s_xor_b32 s82, s67, s33
    s_or_b32 s80, s80, s82
    s_and_b32 s80, s80, 0xff
    s_cbranch_scc0 L_spd_9
    s_add_u32 s81, s81, 1
    s_cmp_ge_u32 s81, 100000
    s_cbranch_scc1 L_spd_9
    s_sleep 1
    s_branch L_sp_8
L_spd_9:
    buffer_load_dwordx4 v[56:59], v34, s[48:51], s40 offen sc1
    buffer_load_dwordx4 v[60:63], v34, s[48:51], s41 offen sc1
    s_and_b32 s52, s52, s72
    s_and_b32 s53, s53, s72
    s_and_b32 s56, s56, s72
    s_and_b32 s57, s57, s72
    s_and_b32 s60, s60, s72
    s_and_b32 s61, s61, s72
    s_and_b32 s64, s64, s72
    s_and_b32 s65, s65, s72
    v_mov_b32 v8, s52
    v_mov_b32 v9, s56
    v_mov_b32 v10, s60
    v_mov_b32 v11, s64
    v_max3_f32 v5, v8, v9, v10
    v_max_f32 v5, v5, v11
    v_sub_f32 v8, v8, v5
    v_sub_f32 v9, v9, v5
    v_sub_f32 v10, v10, v5
    v_sub_f32 v11, v11, v5
    v_exp_f32 v8, v8
    v_exp_f32 v9, v9
    v_exp_f32 v10, v10
    v_exp_f32 v11, v11
    v_mul_f32 v6, s53, v8
    v_fmac_f32 v6, s57, v9
    v_fmac_f32 v6, s61, v10
    v_fmac_f32 v6, s65, v11
    v_rcp_f32 v6, v6
    v_cndmask_b32 v8, v8, v9, s[70:71]
    v_cndmask_b32 v9, v10, v11, s[70:71]
    v_mul_f32 v8, v8, v6
    v_mul_f32 v9, v9, v6
    s_mov_b32 s81, 0
    s_waitcnt vmcnt(0)
    v_perm_b32 v6, v56, v57, s73
    v_perm_b32 v7, v58, v59, s14
    v_or_b32 v6, v6, v7
    v_xor_b32 v5, s34, v6
    v_perm_b32 v6, v60, v61, s73
    v_perm_b32 v7, v62, v63, s14
    v_or_b32 v6, v6, v7
    v_xor_b32 v6, s34, v6
    v_or_b32 v5, v5, v6
    v_cmp_ne_u32 vcc, 0, v5
    s_cbranch_vccz L_vpd_11
L_vp_10:
    buffer_load_dwordx4 v[56:59], v34, s[48:51], s40 offen sc1
    buffer_load_dwordx4 v[60:63], v34, s[48:51], s41 offen sc1
    s_waitcnt vmcnt(0)
    v_perm_b32 v6, v56, v57, s73
    v_perm_b32 v7, v58, v59, s14
    v_or_b32 v6, v6, v7
    v_xor_b32 v5, s34, v6
    v_perm_b32 v6, v60, v61, s73
    v_perm_b32 v7, v62, v63, s14
    v_or_b32 v6, v6, v7
    v_xor_b32 v6, s34, v6
    v_or_b32 v5, v5, v6
    v_cmp_ne_u32 vcc, 0, v5
    s_cbranch_vccz L_vpd_11
    s_add_u32 s81, s81, 1
    s_cmp_ge_u32 s81, 100000
    s_cbranch_scc1 L_vpd_11
    s_sleep 1
    s_branch L_vp_10
L_vpd_11:
    v_and_b32 v56, s72, v56
    v_and_b32 v57, s72, v57
    v_and_b32 v58, s72, v58
    v_and_b32 v59, s72, v59
    v_and_b32 v60, s72, v60
    v_and_b32 v61, s72, v61
    v_and_b32 v62, s72, v62
    v_and_b32 v63, s72, v63
    v_mul_f32 v12, v8, v56
    v_mul_f32 v13, v8, v57
    v_mul_f32 v14, v8, v58
    v_mul_f32 v15, v8, v59
    v_fmac_f32 v12, v9, v60
    v_fmac_f32 v13, v9, v61
    v_fmac_f32 v14, v9, v62
    v_fmac_f32 v15, v9, v63
    v_mov_b32 v16, v12
    v_mov_b32 v17, v13
    v_mov_b32 v18, v14
    v_mov_b32 v19, v15
    v_permlane32_swap_b32 v12, v16
    v_permlane32_swap_b32 v13, v17
    v_permlane32_swap_b32 v14, v18
    v_permlane32_swap_b32 v15, v19
    v_add_f32 v12, v12, v16
    v_add_f32 v13, v13, v17
    v_add_f32 v14, v14, v18
    v_add_f32 v15, v15, v19
    v_cvt_pk_bf16_f32 v12, v12, v13
    v_cvt_pk_bf16_f32 v13, v14, v15
    s_mov_b32 exec_lo, 0xffffffff
    s_mov_b32 exec_hi, 0x0
    ds_write_b64 v35, v[12:13]
    s_mov_b64 exec, -1
    s_waitcnt lgkmcnt(0)
L_nogather_7:
    s_barrier
    s_cmp_lg_u32 s74, 0
    s_cbranch_scc1 L_fin
    s_cmp_eq_u32 s39, 255
    s_cbranch_scc1 L_fin
    s_mul_i32 s76, s35, 28
    s_add_u32 s76, s76, s39
    s_lshl_b32 s77, s76, 11
    s_add_u32 s40, s77, 1048576
    s_add_u32 s41, s40, 1024
    s_lshl_b32 s77, s76, 9
    s_add_u32 s44, s77, 1572864
    v_lshlrev_b32 v3, 4, v0
    v_and_b32 v2, 31, v0
    v_lshlrev_b32 v2, 4, v2
    v_and_b32 v4, 3, v0
    v_lshlrev_b32 v4, 4, v4
    v_add_u32 v4, 109312, v4
    v_mov_b32 v9, 109376
    ds_read_b128 v[24:27], v4
    ds_read_b64 v[14:15], v9
    s_mov_b32 s60, s26
    s_and_b32 s61, s27, 0xffff
    s_mov_b32 s62, 7168
    s_mov_b32 s63, 0x20000
    s_mul_i32 s46, s35, 896
    s_lshl_b32 s78, s39, 5
    s_add_u32 s46, s46, s78
    s_mov_b32 s81, 0
L_vp_12:
    buffer_load_dwordx4 v[28:31], v2, s[48:51], s44 offen sc1
    s_waitcnt vmcnt(0)
    v_perm_b32 v6, v28, v29, s73
    v_perm_b32 v7, v30, v31, s14
    v_or_b32 v6, v6, v7
    v_xor_b32 v5, s34, v6
    v_cmp_ne_u32 vcc, 0, v5
    s_cbranch_vccz L_vpd_13
    s_add_u32 s81, s81, 1
    s_cmp_ge_u32 s81, 100000
    s_cbranch_scc1 L_vpd_13
    s_sleep 1
    s_branch L_vp_12
L_vpd_13:
    buffer_load_dwordx4 v[40:43], v3, s[48:51], s40 offen sc1
    buffer_load_dwordx4 v[44:47], v3, s[48:51], s41 offen sc1
    v_and_b32 v28, s72, v28
    v_and_b32 v29, s72, v29
    v_and_b32 v30, s72, v30
    v_and_b32 v31, s72, v31
    v_cndmask_b32 v28, v28, 0, s[70:71]
    v_cndmask_b32 v29, v29, 0, s[70:71]
    v_cndmask_b32 v30, v30, 0, s[70:71]
    v_cndmask_b32 v31, v31, 0, s[70:71]
    v_add_f32_dpp v28, v28, v28 row_ror:8 row_mask:0xf bank_mask:0xf
    v_add_f32_dpp v29, v29, v29 row_ror:8 row_mask:0xf bank_mask:0xf
    v_add_f32_dpp v30, v30, v30 row_ror:8 row_mask:0xf bank_mask:0xf
    v_add_f32_dpp v31, v31, v31 row_ror:8 row_mask:0xf bank_mask:0xf
    v_add_f32_dpp v28, v28, v28 row_ror:4 row_mask:0xf bank_mask:0xf
    v_add_f32_dpp v29, v29, v29 row_ror:4 row_mask:0xf bank_mask:0xf
    v_add_f32_dpp v30, v30, v30 row_ror:4 row_mask:0xf bank_mask:0xf
    v_add_f32_dpp v31, v31, v31 row_ror:4 row_mask:0xf bank_mask:0xf
    v_mov_b32 v112, v28
    v_mov_b32 v113, v29
    v_mov_b32 v114, v30
    v_mov_b32 v115, v31
    v_permlane16_swap_b32 v28, v112
    v_permlane16_swap_b32 v29, v113
    v_permlane16_swap_b32 v30, v114
    v_permlane16_swap_b32 v31, v115
    v_add_f32 v28, v28, v112
    v_add_f32 v29, v29, v113
    v_add_f32 v30, v30, v114
    v_add_f32 v31, v31, v115
    v_mov_b32 v112, v28
    v_mov_b32 v113, v29
    v_mov_b32 v114, v30
    v_mov_b32 v115, v31
    v_permlane32_swap_b32 v28, v112
    v_permlane32_swap_b32 v29, v113
    v_permlane32_swap_b32 v30, v114
    v_permlane32_swap_b32 v31, v115
    v_add_f32 v28, v28, v112
    v_add_f32 v29, v29, v113
    v_add_f32 v30, v30, v114
    v_add_f32 v31, v31, v115
    s_waitcnt lgkmcnt(0)
    v_cvt_pk_bf16_f32 v16, v28, v29
    v_lshlrev_b32 v28, 16, v16
    v_and_b32 v29, 0xffff0000, v16
    v_add_f32 v28, v28, v24
    v_add_f32 v29, v29, v25
    v_cvt_pk_bf16_f32 v16, v28, v29
    v_lshlrev_b32 v28, 16, v16
    v_and_b32 v29, 0xffff0000, v16
    v_mul_f32 v28, v28, v15
    v_mul_f32 v29, v29, v15
    v_cvt_pk_bf16_f32 v16, v28, v29
    v_lshlrev_b32 v28, 16, v16
    v_and_b32 v29, 0xffff0000, v16
    v_cvt_pk_bf16_f32 v16, v30, v31
    v_lshlrev_b32 v30, 16, v16
    v_and_b32 v31, 0xffff0000, v16
    v_add_f32 v30, v30, v26
    v_add_f32 v31, v31, v27
    v_cvt_pk_bf16_f32 v16, v30, v31
    v_lshlrev_b32 v30, 16, v16
    v_and_b32 v31, 0xffff0000, v16
    v_mul_f32 v30, v30, v15
    v_mul_f32 v31, v31, v15
    v_cvt_pk_bf16_f32 v16, v30, v31
    v_lshlrev_b32 v30, 16, v16
    v_and_b32 v31, 0xffff0000, v16
    s_mov_b32 s81, 0
L_fp_14:
    buffer_load_dwordx4 v[64:67], v3, s[48:51], s40 offen sc1
    buffer_load_dwordx4 v[68:71], v3, s[48:51], s41 offen sc1
    s_waitcnt vmcnt(2)
    v_perm_b32 v6, v40, v41, s73
    v_perm_b32 v7, v42, v43, s14
    v_or_b32 v6, v6, v7
    v_xor_b32 v5, s34, v6
    v_perm_b32 v6, v44, v45, s73
    v_perm_b32 v7, v46, v47, s14
    v_or_b32 v6, v6, v7
    v_xor_b32 v6, s34, v6
    v_or_b32 v5, v5, v6
    v_cmp_ne_u32 vcc, 0, v5
    s_cbranch_vccz L_fpa_15
    buffer_load_dwordx4 v[40:43], v3, s[48:51], s40 offen sc1
    buffer_load_dwordx4 v[44:47], v3, s[48:51], s41 offen sc1
    s_waitcnt vmcnt(2)
    v_perm_b32 v6, v64, v65, s73
    v_perm_b32 v7, v66, v67, s14
    v_or_b32 v6, v6, v7
    v_xor_b32 v5, s34, v6
    v_perm_b32 v6, v68, v69, s73
    v_perm_b32 v7, v70, v71, s14
    v_or_b32 v6, v6, v7
    v_xor_b32 v6, s34, v6
    v_or_b32 v5, v5, v6
    v_cmp_ne_u32 vcc, 0, v5
    s_cbranch_vccz L_fpb_16
    s_add_u32 s81, s81, 1
    s_cmp_lt_u32 s81, 100000
    s_cbranch_scc1 L_fp_14
L_fpb_16:
    v_and_b32 v96, s72, v64
    v_and_b32 v97, s72, v65
    v_and_b32 v98, s72, v66
    v_and_b32 v99, s72, v67
    v_and_b32 v100, s72, v68
    v_and_b32 v101, s72, v69
    v_and_b32 v102, s72, v70
    v_and_b32 v103, s72, v71
    s_branch L_fpo_17
L_fpa_15:
    v_and_b32 v96, s72, v40
    v_and_b32 v97, s72, v41
    v_and_b32 v98, s72, v42
    v_and_b32 v99, s72, v43
    v_and_b32 v100, s72, v44
    v_and_b32 v101, s72, v45
    v_and_b32 v102, s72, v46
    v_and_b32 v103, s72, v47
L_fpo_17:
    v_add_f32 v96, v96, v100
    v_add_f32 v97, v97, v101
    v_add_f32 v98, v98, v102
    v_add_f32 v99, v99, v103
    v_add_f32_dpp v96, v96, v96 row_ror:8 row_mask:0xf bank_mask:0xf
    v_add_f32_dpp v97, v97, v97 row_ror:8 row_mask:0xf bank_mask:0xf
    v_add_f32_dpp v98, v98, v98 row_ror:8 row_mask:0xf bank_mask:0xf
    v_add_f32_dpp v99, v99, v99 row_ror:8 row_mask:0xf bank_mask:0xf
    v_add_f32_dpp v96, v96, v96 row_ror:4 row_mask:0xf bank_mask:0xf
    v_add_f32_dpp v97, v97, v97 row_ror:4 row_mask:0xf bank_mask:0xf
    v_add_f32_dpp v98, v98, v98 row_ror:4 row_mask:0xf bank_mask:0xf
    v_add_f32_dpp v99, v99, v99 row_ror:4 row_mask:0xf bank_mask:0xf
    v_mov_b32 v112, v96
    v_mov_b32 v113, v97
    v_mov_b32 v114, v98
    v_mov_b32 v115, v99
    v_permlane16_swap_b32 v96, v112
    v_permlane16_swap_b32 v97, v113
    v_permlane16_swap_b32 v98, v114
    v_permlane16_swap_b32 v99, v115
    v_add_f32 v96, v96, v112
    v_add_f32 v97, v97, v113
    v_add_f32 v98, v98, v114
    v_add_f32 v99, v99, v115
    v_mov_b32 v112, v96
    v_mov_b32 v113, v97
    v_mov_b32 v114, v98
    v_mov_b32 v115, v99
    v_permlane32_swap_b32 v96, v112
    v_permlane32_swap_b32 v97, v113
    v_permlane32_swap_b32 v98, v114
    v_permlane32_swap_b32 v99, v115
    v_add_f32 v96, v96, v112
    v_add_f32 v97, v97, v113
    v_add_f32 v98, v98, v114
    v_add_f32 v99, v99, v115
    v_cvt_pk_bf16_f32 v16, v96, v97
    v_lshlrev_b32 v96, 16, v16
    v_and_b32 v97, 0xffff0000, v16
    v_mul_f32 v96, v96, v14
    v_mul_f32 v97, v97, v14
    v_cvt_pk_bf16_f32 v16, v96, v97
    v_lshlrev_b32 v96, 16, v16
    v_and_b32 v97, 0xffff0000, v16
    v_add_f32 v96, v96, v28
    v_add_f32 v97, v97, v29
    v_cvt_pk_bf16_f32 v8, v96, v97
    v_cvt_pk_bf16_f32 v16, v98, v99
    v_lshlrev_b32 v98, 16, v16
    v_and_b32 v99, 0xffff0000, v16
    v_mul_f32 v98, v98, v14
    v_mul_f32 v99, v99, v14
    v_cvt_pk_bf16_f32 v16, v98, v99
    v_lshlrev_b32 v98, 16, v16
    v_and_b32 v99, 0xffff0000, v16
    v_add_f32 v98, v98, v30
    v_add_f32 v99, v99, v31
    v_cvt_pk_bf16_f32 v9, v98, v99
    v_lshlrev_b32 v3, 3, v0
    s_mov_b32 exec_lo, 0xf
    s_mov_b32 exec_hi, 0x0
    buffer_store_dwordx2 v[8:9], v3, s[60:63], s46 offen
    s_cmp_lg_u32 s2, 32
    s_cbranch_scc1 L_fin
    v_mov_b32 v8, s32
    v_mov_b32 v3, 0
    s_mov_b32 exec_lo, 0x1
    s_mov_b32 exec_hi, 0x0
    buffer_store_dword v8, v3, s[48:51], 0 offen sc1
    s_branch L_fin
L_helper:
    s_setprio 3
    s_sub_u32 s74, s3, 8
    v_mov_b32 v1, 109440
    v_mov_b32 v2, 0
    v_mov_b32 v3, 0
    v_mov_b32 v4, 0
    v_mov_b32 v5, 0
    s_cmp_lg_u32 s74, 0
    s_cbranch_scc1 L_h_noinit
    s_mov_b32 exec_lo, 0x1
    s_mov_b32 exec_hi, 0x0
    ds_write_b128 v1, v[2:5]
    ds_write_b128 v1, v[2:5] offset:16
    ds_write_b128 v1, v[2:5] offset:32
    s_mov_b64 exec, -1
L_h_noinit:
    s_lshl_b32 s78, s35, 3
    s_mov_b32 s76, 0x10101010
    s_mov_b32 s77, 0x10101010
    s_lshr_b64 s[76:77], s[76:77], s78
    s_and_b32 s40, s76, 0xff
    s_mov_b32 s76, 0x17171717
    s_mov_b32 s77, 0x17171717
    s_lshr_b64 s[76:77], s[76:77], s78
    s_and_b32 s41, s76, 0xff
    s_mov_b32 s76, 0x1e1e1e1e
    s_mov_b32 s77, 0x1e1e1e1e
    s_lshr_b64 s[76:77], s[76:77], s78
    s_and_b32 s42, s76, 0xff
    s_mov_b32 s76, 0x30201000
    s_mov_b32 s77, 0x70605040
    s_lshr_b64 s[76:77], s[76:77], s78
    s_and_b32 s43, s76, 0xff
    s_mov_b32 s76, 0x5fef7f0
    s_mov_b32 s77, 0x211a130c
    s_lshr_b64 s[76:77], s[76:77], s78
    s_and_b32 s44, s76, 0xff
    s_mov_b32 s76, 0xfef7f0e9
    s_mov_b32 s77, 0x1a130c05
    s_lshr_b64 s[76:77], s[76:77], s78
    s_and_b32 s46, s76, 0xff
    s_cmp_lt_u32 s36, s40
    s_cbranch_scc1 L_h_q
    s_cmp_lt_u32 s36, s41
    s_cbranch_scc1 L_h_m1
    s_cmp_lt_u32 s36, s42
    s_cselect_b32 s45, 2, 3
    s_add_u32 s47, s46, s36
    s_and_b32 s47, s47, 0xff
    s_waitcnt lgkmcnt(0)
    s_load_dword s32, s[30:31], 0
    s_mov_b32 s14, 0x04000c0c
    s_mov_b32 s48, s30
    s_and_b32 s49, s31, 0xffff
    s_mov_b32 s50, 8388608
    s_mov_b32 s51, 0x20000
    s_barrier
    s_waitcnt lgkmcnt(0)
    s_add_u32 s32, s32, 1
    s_and_b32 s33, s32, 0xff
    s_mul_i32 s34, s33, 0x01010101
    s_cmp_eq_u32 s39, 255
    s_cbranch_scc1 L_h_qgather
    s_cmp_lg_u32 s74, 3
    s_cbranch_scc1 L_h_qgather
    s_mov_b32 s56, s4
    s_and_b32 s57, s5, 0xffff
    s_mov_b32 s58, 7168
    s_mov_b32 s59, 0x20000
    s_mul_i32 s75, s35, 896
    v_lshlrev_b32 v3, 4, v0
    v_mov_b32 v8, 0
    v_mov_b32 v9, 0
    v_mov_b32 v10, 0
    v_mov_b32 v11, 0
    s_mov_b32 exec_lo, 0xffffffff
    s_mov_b32 exec_hi, 0xffffff
    buffer_load_dwordx4 v[8:11], v3, s[56:59], s75 offen
    s_mov_b64 exec, -1
    s_mov_b32 s56, s24
    s_and_b32 s57, s25, 0xffff
    s_mov_b32 s58, 896
    s_mov_b32 s59, 0x20000
    buffer_load_dwordx4 v[12:15], v3, s[56:59], 0 offen
    s_mov_b32 s56, s22
    s_and_b32 s57, s23, 0xffff
    s_mov_b32 s58, 896
    s_mov_b32 s59, 0x20000
    s_lshl_b32 s75, s39, 5
    v_and_b32 v4, 3, v0
    v_lshlrev_b32 v4, 3, v4
    buffer_load_dwordx2 v[16:17], v4, s[56:59], s75 offen
    s_waitcnt vmcnt(0)
    v_mov_b32 v24, 0
    v_lshlrev_b32 v25, 16, v8
    v_lshlrev_b32 v26, 16, v12
    v_mul_f32 v25, v25, v26
    v_and_b32 v26, 0xffff0000, v8
    v_and_b32 v27, 0xffff0000, v12
    v_mul_f32 v26, v26, v27
    v_cvt_pk_bf16_f32 v25, v25, v26
    v_lshlrev_b32 v26, 16, v25
    v_and_b32 v25, 0xffff0000, v25
    v_add_f32 v24, v24, v26
    v_add_f32 v24, v24, v25
    v_lshlrev_b32 v25, 16, v9
    v_lshlrev_b32 v26, 16, v13
    v_mul_f32 v25, v25, v26
    v_and_b32 v26, 0xffff0000, v9
    v_and_b32 v27, 0xffff0000, v13
    v_mul_f32 v26, v26, v27
    v_cvt_pk_bf16_f32 v25, v25, v26
    v_lshlrev_b32 v26, 16, v25
    v_and_b32 v25, 0xffff0000, v25
    v_add_f32 v24, v24, v26
    v_add_f32 v24, v24, v25
    v_lshlrev_b32 v25, 16, v10
    v_lshlrev_b32 v26, 16, v14
    v_mul_f32 v25, v25, v26
    v_and_b32 v26, 0xffff0000, v10
    v_and_b32 v27, 0xffff0000, v14
    v_mul_f32 v26, v26, v27
    v_cvt_pk_bf16_f32 v25, v25, v26
    v_lshlrev_b32 v26, 16, v25
    v_and_b32 v25, 0xffff0000, v25
    v_add_f32 v24, v24, v26
    v_add_f32 v24, v24, v25
    v_lshlrev_b32 v25, 16, v11
    v_lshlrev_b32 v26, 16, v15
    v_mul_f32 v25, v25, v26
    v_and_b32 v26, 0xffff0000, v11
    v_and_b32 v27, 0xffff0000, v15
    v_mul_f32 v26, v26, v27
    v_cvt_pk_bf16_f32 v25, v25, v26
    v_lshlrev_b32 v26, 16, v25
    v_and_b32 v25, 0xffff0000, v25
    v_add_f32 v24, v24, v26
    v_add_f32 v24, v24, v25
    s_nop 1
    v_add_f32_dpp v24, v24, v24 row_ror:8 row_mask:0xf bank_mask:0xf
    s_nop 1
    v_add_f32_dpp v24, v24, v24 row_ror:4 row_mask:0xf bank_mask:0xf
    s_nop 1
    v_add_f32_dpp v24, v24, v24 row_ror:2 row_mask:0xf bank_mask:0xf
    s_nop 1
    v_add_f32_dpp v24, v24, v24 row_ror:1 row_mask:0xf bank_mask:0xf
    v_mov_b32 v25, v24
    s_nop 1
    v_permlane16_swap_b32 v24, v25
    v_add_f32 v24, v24, v25
    v_mov_b32 v25, v24
    s_nop 1
    v_permlane32_swap_b32 v24, v25
    v_add_f32 v24, v24, v25
    v_cvt_pk_bf16_f32 v24, v24, v24
    v_and_b32 v24, 0xffff0000, v24
    v_mul_f32 v24, 0xbfb8aa3b, v24
    v_exp_f32 v24, v24
    s_nop 0
    v_add_f32 v24, 1.0, v24
    v_rcp_f32 v24, v24
    s_nop 0
    v_cvt_pk_bf16_f32 v24, v24, v24
    v_and_b32 v24, 0xffff0000, v24
    v_sub_f32 v25, 1.0, v24
    v_cvt_pk_bf16_f32 v25, v25, v25
    v_and_b32 v25, 0xffff0000, v25
    v_lshlrev_b32 v28, 16, v16
    v_and_b32 v29, 0xffff0000, v16
    v_lshlrev_b32 v30, 16, v17
    v_and_b32 v31, 0xffff0000, v17
    v_lshlrev_b32 v4, 1, v4
    v_add_u32 v4, 109312, v4
    v_mov_b32 v5, 109376
    s_mov_b32 exec_lo, 0xf
    s_mov_b32 exec_hi, 0x0
    ds_write_b128 v4, v[28:31]
    s_mov_b32 exec_lo, 0x1
    s_mov_b32 exec_hi, 0x0
    ds_write_b64 v5, v[24:25]
    s_mov_b64 exec, -1
    s_waitcnt lgkmcnt(0)
    s_branch L_h_qgather
L_h_q:
    s_add_u32 s47, s43, s36
    s_and_b32 s47, s47, 0xff
    s_and_b32 s79, s47, 1
    s_lshr_b32 s76, s47, 1
    s_mul_i32 s40, s79, 1835008
    s_lshl_b32 s77, s76, 7
    s_add_u32 s40, s40, s77
    s_mov_b32 s41, 8192
    s_mov_b32 s42, 57344
    s_lshr_b32 s43, s76, 3
    s_lshl_b32 s43, s43, 15
    s_and_b32 s77, s76, 7
    s_lshl_b32 s77, s77, 8
    s_add_u32 s43, s43, s77
    s_lshl_b32 s77, s79, 11
    s_add_u32 s43, s43, s77
    s_add_u32 s43, s43, 65536
    s_mov_b32 s44, 4096
    s_mov_b32 s45, 0
    s_waitcnt lgkmcnt(0)
    s_load_dword s32, s[30:31], 0
    s_mov_b32 s14, 0x04000c0c
    s_mov_b32 s52, s10
    s_and_b32 s53, s11, 0xffff
    s_mov_b32 s54, 3670016
    s_mov_b32 s55, 0x20000
    s_branch L_h_tile
L_h_m1:
    s_add_u32 s47, s44, s36
    s_and_b32 s47, s47, 0xff
    s_and_b32 s79, s47, 1
    s_lshr_b32 s76, s47, 1
    s_mul_i32 s40, s79, 802816
    s_lshl_b32 s77, s76, 7
    s_add_u32 s40, s40, s77
    s_mov_b32 s41, 3584
    s_mul_i32 s42, s79, 448
    s_add_u32 s42, s42, 64768
    s_mul_i32 s43, s79, 57344
    s_lshl_b32 s77, s76, 8
    s_add_u32 s43, s43, s77
    s_add_u32 s43, s43, 327680
    s_mov_b32 s44, 7168
    s_mov_b32 s45, 1
    s_waitcnt lgkmcnt(0)
    s_load_dword s32, s[30:31], 0
    s_mov_b32 s14, 0x04000c0c
    s_mov_b32 s52, s16
    s_and_b32 s53, s17, 0xffff
    s_mov_b32 s54, 1605632
    s_mov_b32 s55, 0x20000
L_h_tile:
    s_and_b32 s75, s74, 1
    s_lshl_b32 s75, s75, 6
    v_lshrrev_b32 v1, 3, v0
    v_bfe_u32 v3, v0, 4, 1
    v_lshlrev_b32 v3, 1, v3
    v_and_b32 v2, 7, v0
    v_xor_b32 v2, v2, v3
    v_lshlrev_b32 v2, 4, v2
    v_mul_lo_u32 v1, v1, s41
    v_xor_b32 v2, s75, v2
    v_xor_b32 v6, 64, v2
    v_add_u32 v6, v1, v6
    v_add_u32 v1, v1, v2
    s_mul_i32 s75, s74, 56
    s_lshl_b32 s76, s75, 7
    s_mul_i32 s75, s75, s41
    s_add_u32 s75, s75, s40
    s_lshl_b32 s77, s41, 3
    s_mov_b32 s56, s4
    s_and_b32 s57, s5, 0xffff
    s_mov_b32 s58, 7168
    s_mov_b32 s59, 0x20000
    v_lshlrev_b32 v3, 4, v0
    s_lshl_b32 s78, s74, 1
    s_mul_i32 s80, s78, 928
    s_mul_i32 s78, s78, 896
    s_cmp_eq_u32 s45, 0
    s_cbranch_scc0 L_h_xfull
    s_mul_i32 s79, s79, 448
    s_add_u32 s78, s78, s79
    s_mov_b32 exec_lo, 0xfffffff
    s_mov_b32 exec_hi, 0x0
    s_branch L_h_xgo
L_h_xfull:
    s_mov_b32 exec_lo, 0xffffffff
    s_mov_b32 exec_hi, 0xffffff
L_h_xgo:
    s_add_u32 m0, s80, 57344
    s_nop 0
    buffer_load_dwordx4 v3, s[56:59], s78 offen lds
    s_add_u32 s78, s78, 896
    s_add_u32 m0, s80, 58272
    s_nop 0
    buffer_load_dwordx4 v3, s[56:59], s78 offen lds
    s_mov_b64 exec, -1
    s_add_u32 m0, s76, 0
    s_nop 0
    buffer_load_dwordx4 v1, s[52:55], s75 offen nt lds
    s_add_u32 s75, s75, s77
    s_add_u32 m0, s76, 1024
    s_nop 0
    buffer_load_dwordx4 v6, s[52:55], s75 offen nt lds
    s_add_u32 s75, s75, s77
    s_add_u32 m0, s76, 2048
    s_nop 0
    buffer_load_dwordx4 v1, s[52:55], s75 offen nt lds
    s_add_u32 s75, s75, s77
    s_add_u32 m0, s76, 3072
    s_nop 0
    buffer_load_dwordx4 v6, s[52:55], s75 offen nt lds
    s_add_u32 s75, s75, s77
    s_add_u32 m0, s76, 4096
    s_nop 0
    buffer_load_dwordx4 v1, s[52:55], s75 offen nt lds
    s_add_u32 s75, s75, s77
    s_add_u32 m0, s76, 5120
    s_nop 0
    buffer_load_dwordx4 v6, s[52:55], s75 offen nt lds
    s_add_u32 s75, s75, s77
    s_add_u32 m0, s76, 6144
    s_nop 0
    buffer_load_dwordx4 v1, s[52:55], s75 offen nt lds
    s_add_u32 s75, s75, s77
    s_mov_b32 s48, s30
    s_and_b32 s49, s31, 0xffff
    s_mov_b32 s50, 8388608
    s_mov_b32 s51, 0x20000
    s_barrier
    s_waitcnt lgkmcnt(0)
    s_add_u32 s32, s32, 1
    s_and_b32 s33, s32, 0xff
    s_mul_i32 s34, s33, 0x01010101
    s_waitcnt vmcnt(0)
    v_mov_b32 v3, 109440
    v_mov_b32 v4, 1
    s_mov_b32 exec_lo, 0x1
    s_mov_b32 exec_hi, 0x0
    ds_add_u32 v3, v4
    s_mov_b64 exec, -1
    v_mov_b32 v3, 109440
    s_mov_b32 s81, 0
L_lw_18:
    ds_read_b32 v4, v3
    s_waitcnt lgkmcnt(0)
    v_readfirstlane_b32 s80, v4
    s_nop 0
    s_cmp_ge_u32 s80, 4
    s_cbranch_scc1 L_lwd_19
    s_add_u32 s81, s81, 1
    s_cmp_ge_u32 s81, 800000
    s_cbranch_scc1 L_lwd_19
    s_sleep 1
    s_branch L_lw_18
L_lwd_19:
    s_cmp_eq_u32 s45, 0
    s_cbranch_scc1 L_h_mm
    s_lshl_b32 s75, s74, 1
    s_mul_i32 s75, s75, 928
    v_lshrrev_b32 v1, 5, v0
    v_mul_u32_u24 v1, 928, v1
    v_and_b32 v2, 31, v0
    v_mul_u32_u24 v2, 28, v2
    v_add_u32 v1, v1, v2
    v_add_u32 v1, s75, v1
    v_add_u32 v2, 57344, v1
    ds_read2_b32 v[8:9], v2 offset0:0 offset1:1
    ds_read2_b32 v[10:11], v2 offset0:2 offset1:3
    ds_read2_b32 v[12:13], v2 offset0:4 offset1:5
    ds_read_b32 v14, v2 offset:24
    s_waitcnt lgkmcnt(0)
    v_lshlrev_b32 v16, 16, v8
    v_and_b32 v17, 0xffff0000, v8
    v_lshlrev_b32 v18, 16, v9
    v_and_b32 v19, 0xffff0000, v9
    v_lshlrev_b32 v20, 16, v10
    v_and_b32 v21, 0xffff0000, v10
    v_lshlrev_b32 v22, 16, v11
    v_and_b32 v23, 0xffff0000, v11
    v_lshlrev_b32 v24, 16, v12
    v_and_b32 v25, 0xffff0000, v12
    v_lshlrev_b32 v26, 16, v13
    v_and_b32 v27, 0xffff0000, v13
    v_lshlrev_b32 v28, 16, v14
    v_and_b32 v29, 0xffff0000, v14
    v_add_f32 v3, v16, v17
    v_add_f32 v3, v3, v18
    v_add_f32 v3, v3, v19
    v_add_f32 v3, v3, v20
    v_add_f32 v3, v3, v21
    v_add_f32 v3, v3, v22
    v_add_f32 v3, v3, v23
    v_add_f32 v3, v3, v24
    v_add_f32 v3, v3, v25
    v_add_f32 v3, v3, v26
    v_add_f32 v3, v3, v27
    v_add_f32 v3, v3, v28
    v_add_f32 v3, v3, v29
    s_nop 1
    v_add_f32_dpp v3, v3, v3 row_ror:8 row_mask:0xf bank_mask:0xf
    s_nop 1
    v_add_f32_dpp v3, v3, v3 row_ror:4 row_mask:0xf bank_mask:0xf
    s_nop 1
    v_add_f32_dpp v3, v3, v3 row_ror:2 row_mask:0xf bank_mask:0xf
    s_nop 1
    v_add_f32_dpp v3, v3, v3 row_ror:1 row_mask:0xf bank_mask:0xf
    v_mov_b32 v4, v3
    s_nop 1
    v_permlane16_swap_b32 v3, v4
    v_add_f32 v3, v3, v4
    v_mul_f32 v3, 0x3b124925, v3
    v_sub_f32 v5, v16, v3
    v_mul_f32 v4, v5, v5
    v_sub_f32 v5, v17, v3
    v_fmac_f32 v4, v5, v5
    v_sub_f32 v5, v18, v3
    v_fmac_f32 v4, v5, v5
    v_sub_f32 v5, v19, v3
    v_fmac_f32 v4, v5, v5
    v_sub_f32 v5, v20, v3
    v_fmac_f32 v4, v5, v5
    v_sub_f32 v5, v21, v3
    v_fmac_f32 v4, v5, v5
    v_sub_f32 v5, v22, v3
    v_fmac_f32 v4, v5, v5
    v_sub_f32 v5, v23, v3
    v_fmac_f32 v4, v5, v5
    v_sub_f32 v5, v24, v3
    v_fmac_f32 v4, v5, v5
    v_sub_f32 v5, v25, v3
    v_fmac_f32 v4, v5, v5
    v_sub_f32 v5, v26, v3
    v_fmac_f32 v4, v5, v5
    v_sub_f32 v5, v27, v3
    v_fmac_f32 v4, v5, v5
    v_sub_f32 v5, v28, v3
    v_fmac_f32 v4, v5, v5
    v_sub_f32 v5, v29, v3
    v_fmac_f32 v4, v5, v5
    s_nop 1
    v_add_f32_dpp v4, v4, v4 row_ror:8 row_mask:0xf bank_mask:0xf
    s_nop 1
    v_add_f32_dpp v4, v4, v4 row_ror:4 row_mask:0xf bank_mask:0xf
    s_nop 1
    v_add_f32_dpp v4, v4, v4 row_ror:2 row_mask:0xf bank_mask:0xf
    s_nop 1
    v_add_f32_dpp v4, v4, v4 row_ror:1 row_mask:0xf bank_mask:0xf
    v_mov_b32 v5, v4
    s_nop 1
    v_permlane16_swap_b32 v4, v5
    v_add_f32 v4, v4, v5
    v_mul_f32 v4, 0x3b124925, v4
    v_cvt_pk_bf16_f32 v3, v3, v3
    v_and_b32 v3, 0xffff0000, v3
    v_cvt_pk_bf16_f32 v4, v4, v4
    v_and_b32 v4, 0xffff0000, v4
    v_add_f32 v4, 0x3727c5ac, v4
    v_cvt_pk_bf16_f32 v4, v4, v4
    v_and_b32 v4, 0xffff0000, v4
    v_sqrt_f32 v4, v4
    s_nop 0
    v_cvt_pk_bf16_f32 v4, v4, v4
    v_and_b32 v4, 0xffff0000, v4
    v_rcp_f32 v4, v4
    v_add_u32 v2, 64768, v1
    v_sub_f32 v16, v16, v3
    v_sub_f32 v17, v17, v3
    v_cvt_pk_bf16_f32 v5, v16, v17
    v_lshlrev_b32 v6, 16, v5
    v_and_b32 v5, 0xffff0000, v5
    v_mul_f32 v6, v6, v4
    v_mul_f32 v5, v5, v4
    v_cvt_pk_bf16_f32 v8, v6, v5
    ds_write_b32 v2, v8 offset:0
    v_sub_f32 v18, v18, v3
    v_sub_f32 v19, v19, v3
    v_cvt_pk_bf16_f32 v5, v18, v19
    v_lshlrev_b32 v6, 16, v5
    v_and_b32 v5, 0xffff0000, v5
    v_mul_f32 v6, v6, v4
    v_mul_f32 v5, v5, v4
    v_cvt_pk_bf16_f32 v9, v6, v5
    ds_write_b32 v2, v9 offset:4
    v_sub_f32 v20, v20, v3
    v_sub_f32 v21, v21, v3
    v_cvt_pk_bf16_f32 v5, v20, v21
    v_lshlrev_b32 v6, 16, v5
    v_and_b32 v5, 0xffff0000, v5
    v_mul_f32 v6, v6, v4
    v_mul_f32 v5, v5, v4
    v_cvt_pk_bf16_f32 v10, v6, v5
    ds_write_b32 v2, v10 offset:8
    v_sub_f32 v22, v22, v3
    v_sub_f32 v23, v23, v3
    v_cvt_pk_bf16_f32 v5, v22, v23
    v_lshlrev_b32 v6, 16, v5
    v_and_b32 v5, 0xffff0000, v5
    v_mul_f32 v6, v6, v4
    v_mul_f32 v5, v5, v4
    v_cvt_pk_bf16_f32 v11, v6, v5
    ds_write_b32 v2, v11 offset:12
    v_sub_f32 v24, v24, v3
    v_sub_f32 v25, v25, v3
    v_cvt_pk_bf16_f32 v5, v24, v25
    v_lshlrev_b32 v6, 16, v5
    v_and_b32 v5, 0xffff0000, v5
    v_mul_f32 v6, v6, v4
    v_mul_f32 v5, v5, v4
    v_cvt_pk_bf16_f32 v12, v6, v5
    ds_write_b32 v2, v12 offset:16
    v_sub_f32 v26, v26, v3
    v_sub_f32 v27, v27, v3
    v_cvt_pk_bf16_f32 v5, v26, v27
    v_lshlrev_b32 v6, 16, v5
    v_and_b32 v5, 0xffff0000, v5
    v_mul_f32 v6, v6, v4
    v_mul_f32 v5, v5, v4
    v_cvt_pk_bf16_f32 v13, v6, v5
    ds_write_b32 v2, v13 offset:20
    v_sub_f32 v28, v28, v3
    v_sub_f32 v29, v29, v3
    v_cvt_pk_bf16_f32 v5, v28, v29
    v_lshlrev_b32 v6, 16, v5
    v_and_b32 v5, 0xffff0000, v5
    v_mul_f32 v6, v6, v4
    v_mul_f32 v5, v5, v4
    v_cvt_pk_bf16_f32 v14, v6, v5
    ds_write_b32 v2, v14 offset:24
    s_waitcnt lgkmcnt(0)
    v_mov_b32 v3, 109444
    v_mov_b32 v4, 1
    s_mov_b32 exec_lo, 0x1
    s_mov_b32 exec_hi, 0x0
    ds_add_u32 v3, v4
    s_mov_b64 exec, -1
    v_mov_b32 v3, 109444
    s_mov_b32 s81, 0
L_lw_20:
    ds_read_b32 v4, v3
    s_waitcnt lgkmcnt(0)
    v_readfirstlane_b32 s80, v4
    s_nop 0
    s_cmp_ge_u32 s80, 4
    s_cbranch_scc1 L_lwd_21
    s_add_u32 s81, s81, 1
    s_cmp_ge_u32 s81, 800000
    s_cbranch_scc1 L_lwd_21
    s_sleep 1
    s_branch L_lw_20
L_lwd_21:
L_h_mm:
    v_lshrrev_b32 v1, 4, v0
    v_lshlrev_b32 v1, 3, v1
    v_bfe_u32 v2, v0, 2, 2
    v_add_u32 v1, v1, v2
    v_lshlrev_b32 v1, 7, v1
    v_bfe_u32 v2, v0, 3, 2
    v_xor_b32 v2, s74, v2
    v_lshl_add_u32 v1, v2, 5, v1
    v_and_b32 v2, 3, v0
    v_lshl_add_u32 v1, v2, 3, v1
    v_add_u32 v1, 0, v1
    v_and_b32 v2, 7, v0
    v_mul_u32_u24 v2, 928, v2
    v_lshrrev_b32 v3, 4, v0
    v_lshl_add_u32 v2, v3, 4, v2
    v_add_u32 v2, s42, v2
    ds_read_b64_tr_b16 v[8:9], v1 offset:0
    ds_read_b64_tr_b16 v[10:11], v1 offset:512
    ds_read_b128 v[40:43], v2 offset:0
    ds_read_b64_tr_b16 v[12:13], v1 offset:4096
    ds_read_b64_tr_b16 v[14:15], v1 offset:4608
    ds_read_b128 v[44:47], v2 offset:64
    ds_read_b64_tr_b16 v[16:17], v1 offset:8192
    ds_read_b64_tr_b16 v[18:19], v1 offset:8704
    ds_read_b128 v[48:51], v2 offset:128
    ds_read_b64_tr_b16 v[20:21], v1 offset:12288
    ds_read_b64_tr_b16 v[22:23], v1 offset:12800
    ds_read_b128 v[52:55], v2 offset:192
    s_waitcnt lgkmcnt(9)
    v_mfma_f32_16x16x32_bf16 v[4:7], v[40:43], v[8:11], 0
    ds_read_b64_tr_b16 v[24:25], v1 offset:16384
    ds_read_b64_tr_b16 v[26:27], v1 offset:16896
    ds_read_b128 v[56:59], v2 offset:256
    s_waitcnt lgkmcnt(9)
    v_mfma_f32_16x16x32_bf16 v[4:7], v[44:47], v[12:15], v[4:7]
    ds_read_b64_tr_b16 v[28:29], v1 offset:20480
    ds_read_b64_tr_b16 v[30:31], v1 offset:20992
    ds_read_b128 v[60:63], v2 offset:320
    s_waitcnt lgkmcnt(9)
    v_mfma_f32_16x16x32_bf16 v[4:7], v[48:51], v[16:19], v[4:7]
    ds_read_b64_tr_b16 v[32:33], v1 offset:24576
    ds_read_b64_tr_b16 v[34:35], v1 offset:25088
    ds_read_b128 v[64:67], v2 offset:384
    s_waitcnt lgkmcnt(9)
    v_mfma_f32_16x16x32_bf16 v[4:7], v[52:55], v[20:23], v[4:7]
    s_waitcnt lgkmcnt(6)
    v_mfma_f32_16x16x32_bf16 v[4:7], v[56:59], v[24:27], v[4:7]
    s_waitcnt lgkmcnt(3)
    v_mfma_f32_16x16x32_bf16 v[4:7], v[60:63], v[28:31], v[4:7]
    s_waitcnt lgkmcnt(0)
    v_mfma_f32_16x16x32_bf16 v[4:7], v[64:67], v[32:35], v[4:7]
    s_lshl_b32 s75, s74, 6
    s_add_u32 s43, s43, s75
    s_nop 7
    s_lshl_b32 s80, s74, 9
    s_add_u32 s80, s80, 109568
    v_lshrrev_b32 v70, 4, v0
    v_lshlrev_b32 v70, 8, v70
    v_and_b32 v71, 15, v0
    v_lshl_add_u32 v70, v71, 2, v70
    v_add_u32 v70, s80, v70
    s_mov_b32 exec_lo, 0xffffffff
    s_mov_b32 exec_hi, 0x0
    ds_write_b32 v70, v4 offset:0
    ds_write_b32 v70, v5 offset:64
    ds_write_b32 v70, v6 offset:128
    ds_write_b32 v70, v7 offset:192
    v_lshlrev_b32 v71, 4, v0
    v_add_u32 v71, s80, v71
    ds_read_b128 v[72:75], v71
    v_lshrrev_b32 v70, 2, v0
    v_mul_lo_u32 v70, v70, s44
    v_and_b32 v71, 3, v0
    v_lshl_add_u32 v70, v71, 4, v70
    v_mov_b32 v71, s33
    s_waitcnt lgkmcnt(0)
    v_and_or_b32 v72, v72, s72, v71
    v_and_or_b32 v73, v73, s72, v71
    v_and_or_b32 v74, v74, s72, v71
    v_and_or_b32 v75, v75, s72, v71
    buffer_store_dwordx4 v[72:75], v70, s[48:51], s43 offen sc1
    s_mov_b64 exec, -1
L_h_qgather:
    s_lshl_b32 s75, s35, 3
    s_add_u32 s75, s75, s37
    s_lshl_b32 s75, s75, 12
    s_lshl_b32 s76, s74, 9
    s_add_u32 s75, s75, s76
    s_add_u32 s43, s75, 65536
    v_lshrrev_b32 v1, 5, v0
    v_lshlrev_b32 v1, 11, v1
    v_and_b32 v2, 31, v0
    v_lshl_add_u32 v1, v2, 4, v1
    s_add_u32 s76, s43, 60
    s_add_u32 s78, s30, s76
    s_addc_u32 s79, s31, 0
    s_mov_b32 s81, 0
L_sp_22:
    s_load_dword s52, s[78:79], 2496 glc
    s_waitcnt lgkmcnt(0)
    s_xor_b32 s80, s52, s33
    s_and_b32 s80, s80, 0xff
    s_cbranch_scc0 L_spd_23
    s_add_u32 s81, s81, 1
    s_cmp_ge_u32 s81, 100000
    s_cbranch_scc1 L_spd_23
    s_sleep 8
    s_branch L_sp_22
L_spd_23:
    s_add_u32 s78, s30, s76
    s_addc_u32 s79, s31, 0
    s_mov_b32 s81, 0
L_sp_24:
    s_load_dword s52, s[78:79], 0 glc
    s_load_dword s53, s[78:79], 64 glc
    s_load_dword s54, s[78:79], 128 glc
    s_load_dword s55, s[78:79], 192 glc
    s_load_dword s56, s[78:79], 256 glc
    s_load_dword s57, s[78:79], 320 glc
    s_load_dword s58, s[78:79], 384 glc
    s_load_dword s59, s[78:79], 448 glc
    s_load_dword s60, s[78:79], 2048 glc
    s_load_dword s61, s[78:79], 2112 glc
    s_load_dword s62, s[78:79], 2176 glc
    s_load_dword s63, s[78:79], 2240 glc
    s_load_dword s64, s[78:79], 2304 glc
    s_load_dword s65, s[78:79], 2368 glc
    s_load_dword s66, s[78:79], 2432 glc
    s_load_dword s67, s[78:79], 2496 glc
    s_waitcnt lgkmcnt(0)
    s_xor_b32 s80, s52, s33
    s_xor_b32 s82, s53, s33
    s_or_b32 s80, s80, s82
    s_xor_b32 s82, s54, s33
    s_or_b32 s80, s80, s82
    s_xor_b32 s82, s55, s33
    s_or_b32 s80, s80, s82
    s_xor_b32 s82, s56, s33
    s_or_b32 s80, s80, s82
    s_xor_b32 s82, s57, s33
    s_or_b32 s80, s80, s82
    s_xor_b32 s82, s58, s33
    s_or_b32 s80, s80, s82
    s_xor_b32 s82, s59, s33
    s_or_b32 s80, s80, s82
    s_xor_b32 s82, s60, s33
    s_or_b32 s80, s80, s82
    s_xor_b32 s82, s61, s33
    s_or_b32 s80, s80, s82
    s_xor_b32 s82, s62, s33
    s_or_b32 s80, s80, s82
    s_xor_b32 s82, s63, s33
    s_or_b32 s80, s80, s82
    s_xor_b32 s82, s64, s33
    s_or_b32 s80, s80, s82
    s_xor_b32 s82, s65, s33
    s_or_b32 s80, s80, s82
    s_xor_b32 s82, s66, s33
    s_or_b32 s80, s80, s82
    s_xor_b32 s82, s67, s33
    s_or_b32 s80, s80, s82
    s_and_b32 s80, s80, 0xff
    s_cbranch_scc0 L_spd_25
    s_add_u32 s81, s81, 1
    s_cmp_ge_u32 s81, 100000
    s_cbranch_scc1 L_spd_25
    s_sleep 2
    s_branch L_sp_24
L_spd_25:
    buffer_load_dwordx4 v[8:11], v1, s[48:51], s43 offen sc1
    s_cmp_eq_u32 s45, 2
    s_cbranch_scc1 L_h_qh
    s_mov_b32 s81, 0
    s_waitcnt vmcnt(0)
    v_perm_b32 v6, v8, v9, s73
    v_perm_b32 v7, v10, v11, s14
    v_or_b32 v6, v6, v7
    v_xor_b32 v5, s34, v6
    v_cmp_ne_u32 vcc, 0, v5
    s_cbranch_vccz L_vpd_27
L_vp_26:
    buffer_load_dwordx4 v[8:11], v1, s[48:51], s43 offen sc1
    s_waitcnt vmcnt(0)
    v_perm_b32 v6, v8, v9, s73
    v_perm_b32 v7, v10, v11, s14
    v_or_b32 v6, v6, v7
    v_xor_b32 v5, s34, v6
    v_cmp_ne_u32 vcc, 0, v5
    s_cbranch_vccz L_vpd_27
    s_add_u32 s81, s81, 1
    s_cmp_ge_u32 s81, 100000
    s_cbranch_scc1 L_vpd_27
    s_sleep 8
    s_branch L_vp_26
L_vpd_27:
    v_and_b32 v8, s72, v8
    v_and_b32 v9, s72, v9
    v_and_b32 v10, s72, v10
    v_and_b32 v11, s72, v11
    v_mov_b32 v12, v8
    v_mov_b32 v13, v9
    v_mov_b32 v14, v10
    v_mov_b32 v15, v11
    v_permlane32_swap_b32 v8, v12
    v_permlane32_swap_b32 v9, v13
    v_permlane32_swap_b32 v10, v14
    v_permlane32_swap_b32 v11, v15
    v_add_f32 v8, v8, v12
    v_add_f32 v9, v9, v13
    v_add_f32 v10, v10, v14
    v_add_f32 v11, v11, v15
    v_cvt_pk_bf16_f32 v8, v8, v9
    v_cvt_pk_bf16_f32 v9, v10, v11
    s_lshl_b32 s75, s74, 8
    s_add_u32 s75, s75, 88576
    v_and_b32 v2, 31, v0
    v_lshlrev_b32 v2, 3, v2
    v_add_u32 v2, s75, v2
    s_mov_b32 exec_lo, 0xffffffff
    s_mov_b32 exec_hi, 0x0
    ds_write_b64 v2, v[8:9]
    s_mov_b64 exec, -1
    s_waitcnt lgkmcnt(0)
    v_mov_b32 v3, 109452
    v_mov_b32 v4, 1
    s_mov_b32 exec_lo, 0x1
    s_mov_b32 exec_hi, 0x0
    ds_add_u32 v3, v4
    s_mov_b64 exec, -1
    s_branch L_h_noh
L_h_qh:
    s_lshl_b32 s75, s74, 1
    s_mul_i32 s76, s75, 7168
    s_mul_i32 s77, s75, 928
    s_and_b32 s78, s47, 7
    s_mul_i32 s79, s78, 896
    s_add_u32 s76, s76, s79
    s_add_u32 s40, s76, 327680
    s_add_u32 s46, s77, 64768
    s_mul_i32 s44, s78, 448
    v_min_u32 v61, 55, v0
    v_lshlrev_b32 v60, 4, v61
    v_lshlrev_b32 v61, 3, v61
    v_add_u32 v62, s46, v61
    s_add_u32 s75, s40, 7228
    s_add_u32 s78, s30, s75
    s_addc_u32 s79, s31, 0
    s_mov_b32 s81, 0
L_sp_28:
    s_load_dword s52, s[78:79], 58176 glc
    s_waitcnt lgkmcnt(0)
    s_xor_b32 s80, s52, s33
    s_and_b32 s80, s80, 0xff
    s_cbranch_scc0 L_spd_29
    s_add_u32 s81, s81, 1
    s_cmp_ge_u32 s81, 100000
    s_cbranch_scc1 L_spd_29
    s_sleep 8
    s_branch L_sp_28
L_spd_29:
    s_add_u32 s78, s30, s75
    s_addc_u32 s79, s31, 0
    s_mov_b32 s81, 0
L_sp_30:
    s_load_dword s52, s[78:79], 0 glc
    s_load_dword s53, s[78:79], 64 glc
    s_load_dword s54, s[78:79], 128 glc
    s_load_dword s55, s[78:79], 192 glc
    s_load_dword s56, s[78:79], 256 glc
    s_load_dword s57, s[78:79], 320 glc
    s_load_dword s58, s[78:79], 384 glc
    s_load_dword s59, s[78:79], 448 glc
    s_load_dword s60, s[78:79], 512 glc
    s_load_dword s61, s[78:79], 576 glc
    s_load_dword s62, s[78:79], 640 glc
    s_load_dword s63, s[78:79], 704 glc
    s_load_dword s64, s[78:79], 768 glc
    s_load_dword s65, s[78:79], 832 glc
    s_waitcnt lgkmcnt(0)
    s_xor_b32 s80, s52, s33
    s_xor_b32 s82, s53, s33
    s_or_b32 s80, s80, s82
    s_xor_b32 s82, s54, s33
    s_or_b32 s80, s80, s82
    s_xor_b32 s82, s55, s33
    s_or_b32 s80, s80, s82
    s_xor_b32 s82, s56, s33
    s_or_b32 s80, s80, s82
    s_xor_b32 s82, s57, s33
    s_or_b32 s80, s80, s82
    s_xor_b32 s82, s58, s33
    s_or_b32 s80, s80, s82
    s_xor_b32 s82, s59, s33
    s_or_b32 s80, s80, s82
    s_xor_b32 s82, s60, s33
    s_or_b32 s80, s80, s82
    s_xor_b32 s82, s61, s33
    s_or_b32 s80, s80, s82
    s_xor_b32 s82, s62, s33
    s_or_b32 s80, s80, s82
    s_xor_b32 s82, s63, s33
    s_or_b32 s80, s80, s82
    s_xor_b32 s82, s64, s33
    s_or_b32 s80, s80, s82
    s_xor_b32 s82, s65, s33
    s_or_b32 s80, s80, s82
    s_and_b32 s80, s80, 0xff
    s_cbranch_scc0 L_spd_31
    s_add_u32 s81, s81, 1
    s_cmp_ge_u32 s81, 100000
    s_cbranch_scc1 L_spd_31
    s_sleep 2
    s_branch L_sp_30
L_spd_31:
    s_add_u32 s78, s30, s75
    s_addc_u32 s79, s31, 0
    s_mov_b32 s81, 0
L_sp_32:
    s_load_dword s52, s[78:79], 57344 glc
    s_load_dword s53, s[78:79], 57408 glc
    s_load_dword s54, s[78:79], 57472 glc
    s_load_dword s55, s[78:79], 57536 glc
    s_load_dword s56, s[78:79], 57600 glc
    s_load_dword s57, s[78:79], 57664 glc
    s_load_dword s58, s[78:79], 57728 glc
    s_load_dword s59, s[78:79], 57792 glc
    s_load_dword s60, s[78:79], 57856 glc
    s_load_dword s61, s[78:79], 57920 glc
    s_load_dword s62, s[78:79], 57984 glc
    s_load_dword s63, s[78:79], 58048 glc
    s_load_dword s64, s[78:79], 58112 glc
    s_load_dword s65, s[78:79], 58176 glc
    s_waitcnt lgkmcnt(0)
    s_xor_b32 s80, s52, s33
    s_xor_b32 s82, s53, s33
    s_or_b32 s80, s80, s82
    s_xor_b32 s82, s54, s33
    s_or_b32 s80, s80, s82
    s_xor_b32 s82, s55, s33
    s_or_b32 s80, s80, s82
    s_xor_b32 s82, s56, s33
    s_or_b32 s80, s80, s82
    s_xor_b32 s82, s57, s33
    s_or_b32 s80, s80, s82
    s_xor_b32 s82, s58, s33
    s_or_b32 s80, s80, s82
    s_xor_b32 s82, s59, s33
    s_or_b32 s80, s80, s82
    s_xor_b32 s82, s60, s33
    s_or_b32 s80, s80, s82
    s_xor_b32 s82, s61, s33
    s_or_b32 s80, s80, s82
    s_xor_b32 s82, s62, s33
    s_or_b32 s80, s80, s82
    s_xor_b32 s82, s63, s33
    s_or_b32 s80, s80, s82
    s_xor_b32 s82, s64, s33
    s_or_b32 s80, s80, s82
    s_xor_b32 s82, s65, s33
    s_or_b32 s80, s80, s82
    s_and_b32 s80, s80, 0xff
    s_cbranch_scc0 L_spd_33
    s_add_u32 s81, s81, 1
    s_cmp_ge_u32 s81, 100000
    s_cbranch_scc1 L_spd_33
    s_sleep 2
    s_branch L_sp_32
L_spd_33:
    s_mov_b32 s64, s40
    s_add_u32 s65, s40, 57344
    s_add_u32 s66, s40, 7168
    s_add_u32 s67, s65, 7168
    s_mov_b32 s56, s18
    s_and_b32 s57, s19, 0xffff
    s_mov_b32 s58, 3584
    s_mov_b32 s59, 0x20000
    buffer_load_dwordx2 v[48:49], v61, s[56:59], s44 offen
    buffer_load_dwordx4 v[16:19], v60, s[48:51], s64 offen sc1
    buffer_load_dwordx4 v[20:23], v60, s[48:51], s65 offen sc1
    buffer_load_dwordx4 v[24:27], v60, s[48:51], s66 offen sc1
    buffer_load_dwordx4 v[28:31], v60, s[48:51], s67 offen sc1
    s_mov_b32 s81, 0
    s_waitcnt vmcnt(5)
    v_perm_b32 v6, v8, v9, s73
    v_perm_b32 v7, v10, v11, s14
    v_or_b32 v6, v6, v7
    v_xor_b32 v5, s34, v6
    v_cmp_ne_u32 vcc, 0, v5
    s_cbranch_vccz L_vpd_35
L_vp_34:
    buffer_load_dwordx4 v[8:11], v1, s[48:51], s43 offen sc1
    s_waitcnt vmcnt(0)
    v_perm_b32 v6, v8, v9, s73
    v_perm_b32 v7, v10, v11, s14
    v_or_b32 v6, v6, v7
    v_xor_b32 v5, s34, v6
    v_cmp_ne_u32 vcc, 0, v5
    s_cbranch_vccz L_vpd_35
    s_add_u32 s81, s81, 1
    s_cmp_ge_u32 s81, 100000
    s_cbranch_scc1 L_vpd_35
    s_sleep 8
    s_branch L_vp_34
L_vpd_35:
    v_and_b32 v8, s72, v8
    v_and_b32 v9, s72, v9
    v_and_b32 v10, s72, v10
    v_and_b32 v11, s72, v11
    v_mov_b32 v12, v8
    v_mov_b32 v13, v9
    v_mov_b32 v14, v10
    v_mov_b32 v15, v11
    v_permlane32_swap_b32 v8, v12
    v_permlane32_swap_b32 v9, v13
    v_permlane32_swap_b32 v10, v14
    v_permlane32_swap_b32 v11, v15
    v_add_f32 v8, v8, v12
    v_add_f32 v9, v9, v13
    v_add_f32 v10, v10, v14
    v_add_f32 v11, v11, v15
    v_cvt_pk_bf16_f32 v8, v8, v9
    v_cvt_pk_bf16_f32 v9, v10, v11
    s_lshl_b32 s75, s74, 8
    s_add_u32 s75, s75, 88576
    v_and_b32 v2, 31, v0
    v_lshlrev_b32 v2, 3, v2
    v_add_u32 v2, s75, v2
    s_mov_b32 exec_lo, 0xffffffff
    s_mov_b32 exec_hi, 0x0
    ds_write_b64 v2, v[8:9]
    s_mov_b64 exec, -1
    s_waitcnt lgkmcnt(0)
    v_mov_b32 v3, 109452
    v_mov_b32 v4, 1
    s_mov_b32 exec_lo, 0x1
    s_mov_b32 exec_hi, 0x0
    ds_add_u32 v3, v4
    s_mov_b64 exec, -1
    s_mov_b32 s81, 0
    s_waitcnt vmcnt(0)
    v_perm_b32 v6, v16, v17, s73
    v_perm_b32 v7, v18, v19, s14
    v_or_b32 v6, v6, v7
    v_xor_b32 v5, s34, v6
    v_perm_b32 v6, v20, v21, s73
    v_perm_b32 v7, v22, v23, s14
    v_or_b32 v6, v6, v7
    v_xor_b32 v6, s34, v6
    v_or_b32 v5, v5, v6
    v_perm_b32 v6, v24, v25, s73
    v_perm_b32 v7, v26, v27, s14
    v_or_b32 v6, v6, v7
    v_xor_b32 v6, s34, v6
    v_or_b32 v5, v5, v6
    v_perm_b32 v6, v28, v29, s73
    v_perm_b32 v7, v30, v31, s14
    v_or_b32 v6, v6, v7
    v_xor_b32 v6, s34, v6
    v_or_b32 v5, v5, v6
    v_cmp_ne_u32 vcc, 0, v5
    s_cbranch_vccz L_vpd_37
L_vp_36:
    buffer_load_dwordx4 v[16:19], v60, s[48:51], s64 offen sc1
    buffer_load_dwordx4 v[20:23], v60, s[48:51], s65 offen sc1
    buffer_load_dwordx4 v[24:27], v60, s[48:51], s66 offen sc1
    buffer_load_dwordx4 v[28:31], v60, s[48:51], s67 offen sc1
    s_waitcnt vmcnt(0)
    v_perm_b32 v6, v16, v17, s73
    v_perm_b32 v7, v18, v19, s14
    v_or_b32 v6, v6, v7
    v_xor_b32 v5, s34, v6
    v_perm_b32 v6, v20, v21, s73
    v_perm_b32 v7, v22, v23, s14
    v_or_b32 v6, v6, v7
    v_xor_b32 v6, s34, v6
    v_or_b32 v5, v5, v6
    v_perm_b32 v6, v24, v25, s73
    v_perm_b32 v7, v26, v27, s14
    v_or_b32 v6, v6, v7
    v_xor_b32 v6, s34, v6
    v_or_b32 v5, v5, v6
    v_perm_b32 v6, v28, v29, s73
    v_perm_b32 v7, v30, v31, s14
    v_or_b32 v6, v6, v7
    v_xor_b32 v6, s34, v6
    v_or_b32 v5, v5, v6
    v_cmp_ne_u32 vcc, 0, v5
    s_cbranch_vccz L_vpd_37
    s_add_u32 s81, s81, 1
    s_cmp_ge_u32 s81, 100000
    s_cbranch_scc1 L_vpd_37
    s_sleep 8
    s_branch L_vp_36
L_vpd_37:
    v_and_b32 v16, s72, v16
    v_and_b32 v17, s72, v17
    v_and_b32 v18, s72, v18
    v_and_b32 v19, s72, v19
    v_and_b32 v20, s72, v20
    v_and_b32 v21, s72, v21
    v_and_b32 v22, s72, v22
    v_and_b32 v23, s72, v23
    v_and_b32 v24, s72, v24
    v_and_b32 v25, s72, v25
    v_and_b32 v26, s72, v26
    v_and_b32 v27, s72, v27
    v_and_b32 v28, s72, v28
    v_and_b32 v29, s72, v29
    v_and_b32 v30, s72, v30
    v_and_b32 v31, s72, v31
    v_lshlrev_b32 v50, 16, v48
    v_and_b32 v51, 0xffff0000, v48
    v_lshlrev_b32 v52, 16, v49
    v_and_b32 v53, 0xffff0000, v49
    v_add_f32 v16, v16, v20
    v_add_f32 v17, v17, v21
    v_add_f32 v18, v18, v22
    v_add_f32 v19, v19, v23
    v_cvt_pk_bf16_f32 v20, v16, v17
    v_lshlrev_b32 v16, 16, v20
    v_and_b32 v17, 0xffff0000, v20
    v_add_f32 v16, v16, v50
    v_add_f32 v17, v17, v51
    v_cvt_pk_bf16_f32 v20, v16, v17
    v_lshlrev_b32 v16, 16, v20
    v_and_b32 v17, 0xffff0000, v20
    v_cvt_pk_bf16_f32 v20, v18, v19
    v_lshlrev_b32 v18, 16, v20
    v_and_b32 v19, 0xffff0000, v20
    v_add_f32 v18, v18, v52
    v_add_f32 v19, v19, v53
    v_cvt_pk_bf16_f32 v20, v18, v19
    v_lshlrev_b32 v18, 16, v20
    v_and_b32 v19, 0xffff0000, v20
    v_mul_f32 v36, v16, v16
    v_mov_b32 v37, 0xc0135761
    v_fmac_f32 v37, 0xbdd2d3e2, v36
    v_mul_f32 v37, v37, v16
    v_exp_f32 v37, v37
    s_nop 0
    v_add_f32 v37, 1.0, v37
    v_rcp_f32 v37, v37
    s_nop 0
    v_mul_f32 v16, v16, v37
    v_mul_f32 v38, v17, v17
    v_mov_b32 v39, 0xc0135761
    v_fmac_f32 v39, 0xbdd2d3e2, v38
    v_mul_f32 v39, v39, v17
    v_exp_f32 v39, v39
    s_nop 0
    v_add_f32 v39, 1.0, v39
    v_rcp_f32 v39, v39
    s_nop 0
    v_mul_f32 v17, v17, v39
    v_mul_f32 v40, v18, v18
    v_mov_b32 v41, 0xc0135761
    v_fmac_f32 v41, 0xbdd2d3e2, v40
    v_mul_f32 v41, v41, v18
    v_exp_f32 v41, v41
    s_nop 0
    v_add_f32 v41, 1.0, v41
    v_rcp_f32 v41, v41
    s_nop 0
    v_mul_f32 v18, v18, v41
    v_mul_f32 v42, v19, v19
    v_mov_b32 v43, 0xc0135761
    v_fmac_f32 v43, 0xbdd2d3e2, v42
    v_mul_f32 v43, v43, v19
    v_exp_f32 v43, v43
    s_nop 0
    v_add_f32 v43, 1.0, v43
    v_rcp_f32 v43, v43
    s_nop 0
    v_mul_f32 v19, v19, v43
    v_cvt_pk_bf16_f32 v16, v16, v17
    v_cvt_pk_bf16_f32 v17, v18, v19
    ds_write_b64 v62, v[16:17] offset:0
    v_add_f32 v24, v24, v28
    v_add_f32 v25, v25, v29
    v_add_f32 v26, v26, v30
    v_add_f32 v27, v27, v31
    v_cvt_pk_bf16_f32 v28, v24, v25
    v_lshlrev_b32 v24, 16, v28
    v_and_b32 v25, 0xffff0000, v28
    v_add_f32 v24, v24, v50
    v_add_f32 v25, v25, v51
    v_cvt_pk_bf16_f32 v28, v24, v25
    v_lshlrev_b32 v24, 16, v28
    v_and_b32 v25, 0xffff0000, v28
    v_cvt_pk_bf16_f32 v28, v26, v27
    v_lshlrev_b32 v26, 16, v28
    v_and_b32 v27, 0xffff0000, v28
    v_add_f32 v26, v26, v52
    v_add_f32 v27, v27, v53
    v_cvt_pk_bf16_f32 v28, v26, v27
    v_lshlrev_b32 v26, 16, v28
    v_and_b32 v27, 0xffff0000, v28
    v_mul_f32 v36, v24, v24
    v_mov_b32 v37, 0xc0135761
    v_fmac_f32 v37, 0xbdd2d3e2, v36
    v_mul_f32 v37, v37, v24
    v_exp_f32 v37, v37
    s_nop 0
    v_add_f32 v37, 1.0, v37
    v_rcp_f32 v37, v37
    s_nop 0
    v_mul_f32 v24, v24, v37
    v_mul_f32 v38, v25, v25
    v_mov_b32 v39, 0xc0135761
    v_fmac_f32 v39, 0xbdd2d3e2, v38
    v_mul_f32 v39, v39, v25
    v_exp_f32 v39, v39
    s_nop 0
    v_add_f32 v39, 1.0, v39
    v_rcp_f32 v39, v39
    s_nop 0
    v_mul_f32 v25, v25, v39
    v_mul_f32 v40, v26, v26
    v_mov_b32 v41, 0xc0135761
    v_fmac_f32 v41, 0xbdd2d3e2, v40
    v_mul_f32 v41, v41, v26
    v_exp_f32 v41, v41
    s_nop 0
    v_add_f32 v41, 1.0, v41
    v_rcp_f32 v41, v41
    s_nop 0
    v_mul_f32 v26, v26, v41
    v_mul_f32 v42, v27, v27
    v_mov_b32 v43, 0xc0135761
    v_fmac_f32 v43, 0xbdd2d3e2, v42
    v_mul_f32 v43, v43, v27
    v_exp_f32 v43, v43
    s_nop 0
    v_add_f32 v43, 1.0, v43
    v_rcp_f32 v43, v43
    s_nop 0
    v_mul_f32 v27, v27, v43
    v_cvt_pk_bf16_f32 v24, v24, v25
    v_cvt_pk_bf16_f32 v25, v26, v27
    ds_write_b64 v62, v[24:25] offset:928
    s_waitcnt lgkmcnt(0)
L_h_noh:
    s_cmp_eq_u32 s39, 255
    s_cbranch_scc1 L_h_noprep
    s_cmp_lg_u32 s74, 3
    s_cbranch_scc1 L_h_noprep
    s_cmp_ge_u32 s45, 2
    s_cbranch_scc1 L_h_noprep
    s_mov_b32 s56, s4
    s_and_b32 s57, s5, 0xffff
    s_mov_b32 s58, 7168
    s_mov_b32 s59, 0x20000
    s_mul_i32 s75, s35, 896
    v_lshlrev_b32 v3, 4, v0
    v_mov_b32 v8, 0
    v_mov_b32 v9, 0
    v_mov_b32 v10, 0
    v_mov_b32 v11, 0
    s_mov_b32 exec_lo, 0xffffffff
    s_mov_b32 exec_hi, 0xffffff
    buffer_load_dwordx4 v[8:11], v3, s[56:59], s75 offen
    s_mov_b64 exec, -1
    s_mov_b32 s56, s24
    s_and_b32 s57, s25, 0xffff
    s_mov_b32 s58, 896
    s_mov_b32 s59, 0x20000
    buffer_load_dwordx4 v[12:15], v3, s[56:59], 0 offen
    s_mov_b32 s56, s22
    s_and_b32 s57, s23, 0xffff
    s_mov_b32 s58, 896
    s_mov_b32 s59, 0x20000
    s_lshl_b32 s75, s39, 5
    v_and_b32 v4, 3, v0
    v_lshlrev_b32 v4, 3, v4
    buffer_load_dwordx2 v[16:17], v4, s[56:59], s75 offen
    s_waitcnt vmcnt(0)
    v_mov_b32 v24, 0
    v_lshlrev_b32 v25, 16, v8
    v_lshlrev_b32 v26, 16, v12
    v_mul_f32 v25, v25, v26
    v_and_b32 v26, 0xffff0000, v8
    v_and_b32 v27, 0xffff0000, v12
    v_mul_f32 v26, v26, v27
    v_cvt_pk_bf16_f32 v25, v25, v26
    v_lshlrev_b32 v26, 16, v25
    v_and_b32 v25, 0xffff0000, v25
    v_add_f32 v24, v24, v26
    v_add_f32 v24, v24, v25
    v_lshlrev_b32 v25, 16, v9
    v_lshlrev_b32 v26, 16, v13
    v_mul_f32 v25, v25, v26
    v_and_b32 v26, 0xffff0000, v9
    v_and_b32 v27, 0xffff0000, v13
    v_mul_f32 v26, v26, v27
    v_cvt_pk_bf16_f32 v25, v25, v26
    v_lshlrev_b32 v26, 16, v25
    v_and_b32 v25, 0xffff0000, v25
    v_add_f32 v24, v24, v26
    v_add_f32 v24, v24, v25
    v_lshlrev_b32 v25, 16, v10
    v_lshlrev_b32 v26, 16, v14
    v_mul_f32 v25, v25, v26
    v_and_b32 v26, 0xffff0000, v10
    v_and_b32 v27, 0xffff0000, v14
    v_mul_f32 v26, v26, v27
    v_cvt_pk_bf16_f32 v25, v25, v26
    v_lshlrev_b32 v26, 16, v25
    v_and_b32 v25, 0xffff0000, v25
    v_add_f32 v24, v24, v26
    v_add_f32 v24, v24, v25
    v_lshlrev_b32 v25, 16, v11
    v_lshlrev_b32 v26, 16, v15
    v_mul_f32 v25, v25, v26
    v_and_b32 v26, 0xffff0000, v11
    v_and_b32 v27, 0xffff0000, v15
    v_mul_f32 v26, v26, v27
    v_cvt_pk_bf16_f32 v25, v25, v26
    v_lshlrev_b32 v26, 16, v25
    v_and_b32 v25, 0xffff0000, v25
    v_add_f32 v24, v24, v26
    v_add_f32 v24, v24, v25
    s_nop 1
    v_add_f32_dpp v24, v24, v24 row_ror:8 row_mask:0xf bank_mask:0xf
    s_nop 1
    v_add_f32_dpp v24, v24, v24 row_ror:4 row_mask:0xf bank_mask:0xf
    s_nop 1
    v_add_f32_dpp v24, v24, v24 row_ror:2 row_mask:0xf bank_mask:0xf
    s_nop 1
    v_add_f32_dpp v24, v24, v24 row_ror:1 row_mask:0xf bank_mask:0xf
    v_mov_b32 v25, v24
    s_nop 1
    v_permlane16_swap_b32 v24, v25
    v_add_f32 v24, v24, v25
    v_mov_b32 v25, v24
    s_nop 1
    v_permlane32_swap_b32 v24, v25
    v_add_f32 v24, v24, v25
    v_cvt_pk_bf16_f32 v24, v24, v24
    v_and_b32 v24, 0xffff0000, v24
    v_mul_f32 v24, 0xbfb8aa3b, v24
    v_exp_f32 v24, v24
    s_nop 0
    v_add_f32 v24, 1.0, v24
    v_rcp_f32 v24, v24
    s_nop 0
    v_cvt_pk_bf16_f32 v24, v24, v24
    v_and_b32 v24, 0xffff0000, v24
    v_sub_f32 v25, 1.0, v24
    v_cvt_pk_bf16_f32 v25, v25, v25
    v_and_b32 v25, 0xffff0000, v25
    v_lshlrev_b32 v28, 16, v16
    v_and_b32 v29, 0xffff0000, v16
    v_lshlrev_b32 v30, 16, v17
    v_and_b32 v31, 0xffff0000, v17
    v_lshlrev_b32 v4, 1, v4
    v_add_u32 v4, 109312, v4
    v_mov_b32 v5, 109376
    s_mov_b32 exec_lo, 0xf
    s_mov_b32 exec_hi, 0x0
    ds_write_b128 v4, v[28:31]
    s_mov_b32 exec_lo, 0x1
    s_mov_b32 exec_hi, 0x0
    ds_write_b64 v5, v[24:25]
    s_mov_b64 exec, -1
    s_waitcnt lgkmcnt(0)
L_h_noprep:
    v_mov_b32 v3, 109460
    s_mov_b32 s81, 0
L_lw_38:
    ds_read_b32 v4, v3
    s_waitcnt lgkmcnt(0)
    v_readfirstlane_b32 s80, v4
    s_nop 0
    s_cmp_ge_u32 s80, 8
    s_cbranch_scc1 L_lwd_39
    s_add_u32 s81, s81, 1
    s_cmp_ge_u32 s81, 800000
    s_cbranch_scc1 L_lwd_39
    s_sleep 4
    s_branch L_lw_38
L_lwd_39:
    s_setprio 0
    s_cmp_eq_u32 s45, 2
    s_cbranch_scc0 L_h_now2
    s_mov_b32 s52, s20
    s_and_b32 s53, s21, 0xffff
    s_mov_b32 s54, 1605632
    s_mov_b32 s55, 0x20000
    s_and_b32 s76, s47, 7
    s_lshr_b32 s77, s47, 3
    s_mul_i32 s40, s76, 200704
    s_lshl_b32 s78, s77, 7
    s_add_u32 s40, s40, s78
    s_mov_b32 s41, 896
    s_mov_b32 s42, 64768
    s_lshl_b32 s43, s77, 11
    s_lshl_b32 s78, s76, 6
    s_add_u32 s43, s43, s78
    s_lshl_b32 s78, s74, 9
    s_add_u32 s43, s43, s78
    s_add_u32 s46, s43, 1572864
    s_and_b32 s75, s74, 1
    s_lshl_b32 s75, s75, 6
    v_lshrrev_b32 v1, 3, v0
    v_bfe_u32 v3, v0, 4, 1
    v_lshlrev_b32 v3, 1, v3
    v_and_b32 v2, 7, v0
    v_xor_b32 v2, v2, v3
    v_lshlrev_b32 v2, 4, v2
    v_mul_lo_u32 v1, v1, s41
    v_xor_b32 v2, s75, v2
    v_xor_b32 v6, 64, v2
    v_add_u32 v6, v1, v6
    v_add_u32 v1, v1, v2
    s_mul_i32 s75, s74, 56
    s_lshl_b32 s76, s75, 7
    s_mul_i32 s75, s75, 896
    s_add_u32 s75, s75, s40
    s_add_u32 m0, s76, 0
    s_nop 0
    buffer_load_dwordx4 v1, s[52:55], s75 offen nt lds
    s_add_u32 s75, s75, 7168
    s_add_u32 m0, s76, 1024
    s_nop 0
    buffer_load_dwordx4 v6, s[52:55], s75 offen nt lds
    s_add_u32 s75, s75, 7168
    s_add_u32 m0, s76, 2048
    s_nop 0
    buffer_load_dwordx4 v1, s[52:55], s75 offen nt lds
    s_add_u32 s75, s75, 7168
    s_add_u32 m0, s76, 3072
    s_nop 0
    buffer_load_dwordx4 v6, s[52:55], s75 offen nt lds
    s_add_u32 s75, s75, 7168
    s_add_u32 m0, s76, 4096
    s_nop 0
    buffer_load_dwordx4 v1, s[52:55], s75 offen nt lds
    s_add_u32 s75, s75, 7168
    s_add_u32 m0, s76, 5120
    s_nop 0
    buffer_load_dwordx4 v6, s[52:55], s75 offen nt lds
    s_add_u32 s75, s75, 7168
    s_add_u32 m0, s76, 6144
    s_nop 0
    buffer_load_dwordx4 v1, s[52:55], s75 offen nt lds
L_h_now2:
    s_cmp_eq_u32 s39, 255
    s_cbranch_scc1 L_h_nowo
    s_mov_b32 s60, s12
    s_and_b32 s61, s13, 0xffff
    s_mov_b32 s62, 3670016
    s_mov_b32 s63, 0x20000
    s_mov_b32 s41, 896
    s_mov_b32 s75, 0
    v_lshrrev_b32 v1, 3, v0
    v_bfe_u32 v3, v0, 4, 1
    v_lshlrev_b32 v3, 1, v3
    v_and_b32 v2, 7, v0
    v_xor_b32 v2, v2, v3
    v_lshlrev_b32 v2, 4, v2
    v_mul_lo_u32 v1, v1, s41
    v_xor_b32 v2, s75, v2
    v_xor_b32 v6, 64, v2
    v_add_u32 v6, v1, v6
    v_add_u32 v1, v1, v2
    s_and_b32 s75, s39, 3
    s_lshl_b32 s75, s75, 7
    s_lshl_b32 s76, s35, 9
    s_add_u32 s75, s75, s76
    s_lshl_b32 s76, s74, 5
    s_add_u32 s75, s75, s76
    s_mul_i32 s75, s75, 896
    s_lshr_b32 s76, s39, 2
    s_lshl_b32 s76, s76, 7
    s_add_u32 s75, s75, s76
    s_lshl_b32 s76, s74, 12
    s_add_u32 m0, s76, 72192
    s_nop 0
    buffer_load_dwordx4 v1, s[60:63], s75 offen nt lds
    s_add_u32 s75, s75, 7168
    s_add_u32 m0, s76, 73216
    s_nop 0
    buffer_load_dwordx4 v6, s[60:63], s75 offen nt lds
    s_add_u32 s75, s75, 7168
    s_add_u32 m0, s76, 74240
    s_nop 0
    buffer_load_dwordx4 v1, s[60:63], s75 offen nt lds
    s_add_u32 s75, s75, 7168
    s_add_u32 m0, s76, 75264
    s_nop 0
    buffer_load_dwordx4 v6, s[60:63], s75 offen nt lds
L_h_nowo:
    s_setprio 3
    s_barrier
    s_waitcnt vmcnt(0)
    v_mov_b32 v3, 109448
    v_mov_b32 v4, 1
    s_mov_b32 exec_lo, 0x1
    s_mov_b32 exec_hi, 0x0
    ds_add_u32 v3, v4
    s_mov_b64 exec, -1
    v_mov_b32 v3, 109448
    s_mov_b32 s81, 0
L_lw_40:
    ds_read_b32 v4, v3
    s_waitcnt lgkmcnt(0)
    v_readfirstlane_b32 s80, v4
    s_nop 0
    s_cmp_ge_u32 s80, 4
    s_cbranch_scc1 L_lwd_41
    s_add_u32 s81, s81, 1
    s_cmp_ge_u32 s81, 800000
    s_cbranch_scc1 L_lwd_41
    s_sleep 1
    s_branch L_lw_40
L_lwd_41:
    s_cmp_eq_u32 s45, 2
    s_cbranch_scc0 L_h_nom2
    v_lshrrev_b32 v1, 4, v0
    v_lshlrev_b32 v1, 3, v1
    v_bfe_u32 v2, v0, 2, 2
    v_add_u32 v1, v1, v2
    v_lshlrev_b32 v1, 7, v1
    v_bfe_u32 v2, v0, 3, 2
    v_xor_b32 v2, s74, v2
    v_lshl_add_u32 v1, v2, 5, v1
    v_and_b32 v2, 3, v0
    v_lshl_add_u32 v1, v2, 3, v1
    v_add_u32 v1, 0, v1
    v_and_b32 v2, 7, v0
    v_mul_u32_u24 v2, 928, v2
    v_lshrrev_b32 v3, 4, v0
    v_lshl_add_u32 v2, v3, 4, v2
    v_add_u32 v2, s42, v2
    ds_read_b64_tr_b16 v[8:9], v1 offset:0
    ds_read_b64_tr_b16 v[10:11], v1 offset:512
    ds_read_b128 v[40:43], v2 offset:0
    ds_read_b64_tr_b16 v[12:13], v1 offset:4096
    ds_read_b64_tr_b16 v[14:15], v1 offset:4608
    ds_read_b128 v[44:47], v2 offset:64
    ds_read_b64_tr_b16 v[16:17], v1 offset:8192
    ds_read_b64_tr_b16 v[18:19], v1 offset:8704
    ds_read_b128 v[48:51], v2 offset:128
    ds_read_b64_tr_b16 v[20:21], v1 offset:12288
    ds_read_b64_tr_b16 v[22:23], v1 offset:12800
    ds_read_b128 v[52:55], v2 offset:192
    s_waitcnt lgkmcnt(9)
    v_mfma_f32_16x16x32_bf16 v[4:7], v[40:43], v[8:11], 0
    ds_read_b64_tr_b16 v[24:25], v1 offset:16384
    ds_read_b64_tr_b16 v[26:27], v1 offset:16896
    ds_read_b128 v[56:59], v2 offset:256
    s_waitcnt lgkmcnt(9)
    v_mfma_f32_16x16x32_bf16 v[4:7], v[44:47], v[12:15], v[4:7]
    ds_read_b64_tr_b16 v[28:29], v1 offset:20480
    ds_read_b64_tr_b16 v[30:31], v1 offset:20992
    ds_read_b128 v[60:63], v2 offset:320
    s_waitcnt lgkmcnt(9)
    v_mfma_f32_16x16x32_bf16 v[4:7], v[48:51], v[16:19], v[4:7]
    ds_read_b64_tr_b16 v[32:33], v1 offset:24576
    ds_read_b64_tr_b16 v[34:35], v1 offset:25088
    ds_read_b128 v[64:67], v2 offset:384
    s_waitcnt lgkmcnt(9)
    v_mfma_f32_16x16x32_bf16 v[4:7], v[52:55], v[20:23], v[4:7]
    s_waitcnt lgkmcnt(6)
    v_mfma_f32_16x16x32_bf16 v[4:7], v[56:59], v[24:27], v[4:7]
    s_waitcnt lgkmcnt(3)
    v_mfma_f32_16x16x32_bf16 v[4:7], v[60:63], v[28:31], v[4:7]
    s_waitcnt lgkmcnt(0)
    v_mfma_f32_16x16x32_bf16 v[4:7], v[64:67], v[32:35], v[4:7]
    s_mov_b32 s44, 14336
    s_nop 7
    s_lshl_b32 s80, s74, 9
    s_add_u32 s80, s80, 109568
    v_lshrrev_b32 v70, 4, v0
    v_lshlrev_b32 v70, 8, v70
    v_and_b32 v71, 15, v0
    v_lshl_add_u32 v70, v71, 2, v70
    v_add_u32 v70, s80, v70
    s_mov_b32 exec_lo, 0xffffffff
    s_mov_b32 exec_hi, 0x0
    ds_write_b32 v70, v4 offset:0
    ds_write_b32 v70, v5 offset:64
    ds_write_b32 v70, v6 offset:128
    ds_write_b32 v70, v7 offset:192
    v_lshlrev_b32 v71, 4, v0
    v_add_u32 v71, s80, v71
    ds_read_b128 v[72:75], v71
    v_lshrrev_b32 v70, 2, v0
    v_mul_lo_u32 v70, v70, s44
    v_and_b32 v71, 3, v0
    v_lshl_add_u32 v70, v71, 4, v70
    v_mov_b32 v71, s33
    s_waitcnt lgkmcnt(0)
    v_and_or_b32 v72, v72, s72, v71
    v_and_or_b32 v73, v73, s72, v71
    v_and_or_b32 v74, v74, s72, v71
    v_and_or_b32 v75, v75, s72, v71
    buffer_store_dwordx4 v[72:75], v70, s[48:51], s46 offen sc1
    s_mov_b64 exec, -1
L_h_nom2:
    s_cmp_eq_u32 s39, 255
    s_cbranch_scc1 L_h_tail1
    v_lshrrev_b32 v1, 4, v0
    v_lshlrev_b32 v1, 3, v1
    v_bfe_u32 v2, v0, 2, 2
    v_add_u32 v1, v1, v2
    v_lshlrev_b32 v1, 7, v1
    v_bfe_u32 v2, v0, 3, 2
    v_xor_b32 v2, s74, v2
    v_lshl_add_u32 v1, v2, 5, v1
    v_and_b32 v2, 3, v0
    v_lshl_add_u32 v1, v2, 3, v1
    v_add_u32 v1, 72192, v1
    ds_read_b64_tr_b16 v[100:101], v1 offset:0
    ds_read_b64_tr_b16 v[102:103], v1 offset:512
    ds_read_b64_tr_b16 v[104:105], v1 offset:4096
    ds_read_b64_tr_b16 v[106:107], v1 offset:4608
    ds_read_b64_tr_b16 v[108:109], v1 offset:8192
    ds_read_b64_tr_b16 v[110:111], v1 offset:8704
    ds_read_b64_tr_b16 v[112:113], v1 offset:12288
    ds_read_b64_tr_b16 v[114:115], v1 offset:12800
    s_lshr_b32 s75, s39, 2
    s_lshl_b32 s75, s75, 2
    s_add_u32 s75, s75, s74
    s_lshl_b32 s43, s75, 11
    s_lshl_b32 s75, s35, 2
    s_and_b32 s76, s39, 3
    s_add_u32 s75, s75, s76
    s_lshl_b32 s75, s75, 6
    s_add_u32 s43, s43, s75
    s_add_u32 s43, s43, 1048576
    s_mov_b32 s44, 57344
    v_and_b32 v2, 7, v0
    v_mul_u32_u24 v2, 272, v2
    v_lshrrev_b32 v3, 4, v0
    v_lshl_add_u32 v2, v3, 4, v2
    v_add_u32 v2, 107136, v2
    v_lshrrev_b32 v70, 4, v0
    v_lshlrev_b32 v70, 2, v70
    v_mul_lo_u32 v70, v70, s44
    v_and_b32 v71, 15, v0
    v_lshl_add_u32 v70, v71, 2, v70
    v_mov_b32 v71, s33
    s_mul_i32 s76, s44, 0
    s_add_u32 s76, s76, s43
    s_mul_i32 s77, s44, 1
    s_add_u32 s77, s77, s43
    s_mul_i32 s78, s44, 2
    s_add_u32 s78, s78, s43
    s_mul_i32 s79, s44, 3
    s_add_u32 s79, s79, s43
    s_waitcnt lgkmcnt(0)
    s_barrier
    ds_read_b128 v[40:43], v2 offset:0
    ds_read_b128 v[44:47], v2 offset:64
    ds_read_b128 v[48:51], v2 offset:128
    ds_read_b128 v[52:55], v2 offset:192
    s_waitcnt lgkmcnt(3)
    v_mfma_f32_16x16x32_bf16 v[4:7], v[40:43], v[100:103], 0
    s_waitcnt lgkmcnt(2)
    v_mfma_f32_16x16x32_bf16 v[4:7], v[44:47], v[104:107], v[4:7]
    s_waitcnt lgkmcnt(1)
    v_mfma_f32_16x16x32_bf16 v[4:7], v[48:51], v[108:111], v[4:7]
    s_waitcnt lgkmcnt(0)
    v_mfma_f32_16x16x32_bf16 v[4:7], v[52:55], v[112:115], v[4:7]
    s_mov_b32 exec_lo, 0xffffffff
    s_mov_b32 exec_hi, 0x0
    s_nop 5
    v_and_or_b32 v72, v4, s72, v71
    v_and_or_b32 v73, v5, s72, v71
    v_and_or_b32 v74, v6, s72, v71
    v_and_or_b32 v75, v7, s72, v71
    buffer_store_dword v72, v70, s[48:51], s76 offen sc1
    buffer_store_dword v73, v70, s[48:51], s77 offen sc1
    buffer_store_dword v74, v70, s[48:51], s78 offen sc1
    buffer_store_dword v75, v70, s[48:51], s79 offen sc1
    s_branch L_fin
L_h_tail:
    s_barrier
L_h_tail1:
    s_barrier
    s_branch L_fin
L_fin:
L_end:
    s_endpgm
.section .rodata,"a"
.p2align 6
.amdhsa_kernel gated_mix__sliding_block_cached__mixer_channel_mlp__decode_kernel
  .amdhsa_next_free_vgpr 168
  .amdhsa_next_free_sgpr 102
  .amdhsa_accum_offset 168
  .amdhsa_group_segment_fixed_size 0
  .amdhsa_kernarg_size 112
  .amdhsa_user_sgpr_count 2
  .amdhsa_user_sgpr_kernarg_segment_ptr 1
  .amdhsa_system_sgpr_workgroup_id_x 1
.end_amdhsa_kernel
```
